```python
import torch

def _softmax(x, axis=-1):
    return torch.softmax(x, dim=axis)
def _gelu(x):
    return torch.nn.functional.gelu(x, approximate="tanh")
def _silu(x):
    return torch.nn.functional.silu(x)
def _sigmoid(x):
    return torch.sigmoid(x)
def _layernorm(x, axis=-1, eps=1e-5):
    m = x.mean(dim=axis, keepdim=True)
    v = x.var(dim=axis, keepdim=True, unbiased=False)
    return (x - m) / torch.sqrt(v + eps)
def _scatter_add(tgt, idx, src, axis=0):
    return tgt.clone().index_add_(axis, idx, src)
def _segment_sum(src, seg, n):
    out = torch.zeros((n,) + src.shape[1:], dtype=src.dtype)
    return out.index_add_(0, seg, src)
def _pad(x, pw):
    flat = tuple(v for pair in reversed(pw) for v in pair)
    return torch.nn.functional.pad(x, flat)

kernel_name = 'interleave_layers__linear_attn_block__softmax_full_mha__prompt'

def setup_inputs():

    _w = (lambda a: (lambda t: t.to(torch.bfloat16) if t.is_floating_point() else t)(torch.as_tensor(a)))
    def _A_setup():
        B, S, D = 1, 2048, 448
        return {
            "x": _w((lambda *s: torch.randn(*s, dtype=torch.bfloat16) * 0.05)(B, S, D)),
            "wqkv": _w((lambda *s: torch.randn(*s, dtype=torch.bfloat16) * 0.1)(D, 3 * D)),
            "wo": _w((lambda *s: torch.randn(*s, dtype=torch.bfloat16) * 0.05)(D, D)),
        }
    _A_in = _A_setup()

    def _B_setup():
        B, S, D = 1, 2048, 448
        return {
            "x": _w((lambda *s: torch.randn(*s, dtype=torch.bfloat16) * 0.05)(B, S, D)),
            "wqkv": _w((lambda *s: torch.randn(*s, dtype=torch.bfloat16) * 0.1)(D, 3 * D)),
            "wo": _w((lambda *s: torch.randn(*s, dtype=torch.bfloat16) * 0.05)(D, D)),
        }
    _B_in = _B_setup()

    return {
        "A_x": _A_in["x"],
        "A_wqkv": _A_in["wqkv"],
        "A_wo": _A_in["wo"],
        "B_x": _B_in["x"],
        "B_wqkv": _B_in["wqkv"],
        "B_wo": _B_in["wo"],
    }

def reference(A_x, A_wqkv, A_wo, B_x, B_wqkv, B_wo):
    def _A_ref(x, wqkv, wo):
        B, S, D = x.shape
        H = 16; Dh = D // H
        qkv = (lambda x, *d: x.permute(*d))((x @ wqkv).reshape(B, S, 3, H, Dh), 2, 0, 3, 1, 4)
        q, k, v = qkv[0], qkv[1], qkv[2]
        phi = lambda t: torch.where(t > 0, t + 1, torch.exp(t)) + 1e-6
        pq, pk = phi(q), phi(k)
        kv = torch.einsum("bhsd,bhse->bhde", pk, v)
        z = torch.einsum("bhsd->bhd", pk)
        num = torch.einsum("bhqd,bhde->bhqe", pq, kv)
        den = torch.einsum("bhqd,bhd->bhq", pq, z)[..., None] + 1e-6
        o = num / den
        return (lambda x, *d: x.permute(*d))(o, 0, 2, 1, 3).reshape(B, S, D) @ wo

    def _B_ref(x, wqkv, wo):
        B, S, D = x.shape
        H = 16; Dh = D // H
        qkv = (lambda x, *d: x.permute(*d))((x @ wqkv).reshape(B, S, 3, H, Dh), 2, 0, 3, 1, 4)
        q, k, v = qkv[0], qkv[1], qkv[2]
        scale = Dh ** -0.5
        scores = torch.einsum("bhqd,bhkd->bhqk", q, k) * scale
        p = _softmax(scores, axis=-1)
        o = torch.einsum("bhqk,bhkd->bhqd", p, v)
        return (lambda x, *d: x.permute(*d))(o, 0, 2, 1, 3).reshape(B, S, D) @ wo

    x = A_x
    x = x + _A_ref(_layernorm(x, axis=-1), A_wqkv, A_wo)
    x = x + _B_ref(_layernorm(x, axis=-1), B_wqkv, B_wo)
    x = x + _A_ref(_layernorm(x, axis=-1), A_wqkv, A_wo)
    x = x + _B_ref(_layernorm(x, axis=-1), B_wqkv, B_wo)
    return x
```

```asm
; @launch grid=(256,1,1) block=(512,1,1) lds=163840
.amdgcn_target "amdgcn-amd-amdhsa--gfx950"
.text
.globl interleave_layers__linear_attn_block__softmax_full_mha__prompt_kernel
.p2align 8
.type interleave_layers__linear_attn_block__softmax_full_mha__prompt_kernel,@function
interleave_layers__linear_attn_block__softmax_full_mha__prompt_kernel:
    s_cmp_ge_u32 s2, 256
    s_cbranch_scc1 L_end
    s_load_dwordx16 s[64:79], s[0:1], 0
    s_load_dwordx2 s[80:81], s[0:1], 64
    s_getpc_b64 s[88:89]
L_pcref:
    s_sub_u32 s36, s88, L_pcref-interleave_layers__linear_attn_block__softmax_full_mha__prompt_kernel
    s_subb_u32 s37, s89, 0
    s_mov_b32 s38, L_code_end-interleave_layers__linear_attn_block__softmax_full_mha__prompt_kernel
    s_mov_b32 s39, 0x20000
    s_lshr_b32 s55, s2, 3
    s_mul_i32 s56, s55, 52
    s_lshr_b32 s56, s56, 8
    s_mul_i32 s56, s56, 5
    s_sub_u32 s55, s55, s56
    s_lshl_b32 s55, s55, 13
    v_lshlrev_b32 v15, 4, v0
    buffer_load_dwordx4 v[252:255], v15, s[36:39], s55 offen
    v_lshrrev_b32 v14, 6, v0
    v_and_b32 v1, 63, v0
    v_readfirstlane_b32 s40, v14
    v_lshlrev_b32 v2, 4, v1
    s_and_b32 s53, s2, 7
    s_lshr_b32 s54, s2, 3
    s_lshr_b32 s41, s53, 1
    s_lshl_b32 s41, s41, 2
    s_and_b32 s55, s54, 3
    s_add_u32 s41, s41, s55
    s_and_b32 s42, s53, 1
    s_lshl_b32 s42, s42, 3
    s_lshr_b32 s55, s54, 2
    s_add_u32 s42, s42, s55
    s_mov_b32 s44, s55
    s_cmp_lt_u32 s55, 7
    s_cselect_b32 s45, 1, 0
    s_cselect_b32 s44, s44, 0
    s_and_b32 s43, s53, 1
    s_lshl_b32 s56, s41, 1
    s_add_u32 s43, s43, s56
    s_mul_i32 s55, s54, 37
    s_lshr_b32 s55, s55, 8
    s_mul_i32 s56, s55, 7
    s_sub_u32 s84, s54, s56
    s_mov_b32 s46, 0
    s_mov_b32 s47, 0x1000000
    s_mov_b32 s51, 0
    s_lshl_b32 s7, s42, 4
    s_add_u32 s7, s7, s41
    s_mul_i32 s3, s42, 512
    s_mul_i32 s4, s41, 512
    s_lshr_b32 s5, s43, 1
    s_mul_i32 s5, s5, 512
    s_mov_b32 s60, 0xf0000000
    s_mov_b32 s61, 0xf0000000
    v_lshrrev_b32 v16, 5, v1
    v_bfe_u32 v17, v1, 4, 1
    v_bfe_u32 v18, v1, 2, 2
    v_and_b32 v19, 3, v1
    v_lshlrev_b32 v20, 5, v17
    v_lshl_add_u32 v20, v19, 3, v20
    v_lshl_add_u32 v21, v16, 3, v18
    s_and_b32 s56, s42, 1
    s_lshl_b32 s56, s56, 3
    v_add_u32 v24, s56, v20
    v_and_b32 v24, 63, v24
    v_lshl_add_u32 v8, v21, 6, v24
    v_add_u32 v8, 57344, v8
    v_lshl_add_u32 v24, v21, 7, v24
    v_lshrrev_b32 v22, 1, v18
    v_lshl_add_u32 v3, v22, 6, v24
    v_xor_b32 v22, 1, v22
    v_lshl_add_u32 v4, v22, 6, v24
    v_lshl_add_u32 v21, v16, 2, v18
    v_lshlrev_b32 v21, 7, v21
    v_add_u32 v21, v21, v20
    v_add_u32 v21, 86016, v21
    v_lshrrev_b32 v22, 1, v18
    v_and_b32 v23, 31, v1
    v_mul_u32_u24 v7, 896, v23
    v_lshl_add_u32 v7, v16, 4, v7
    v_cmp_eq_u32 vcc, 28, v23
    v_mov_b32 v24, 0x3f803f80
    s_nop 0
    v_cndmask_b32 v9, 0, v24, vcc
    s_lshr_b32 s53, s40, 1
    s_and_b32 s53, s53, 1
    v_xor_b32 v22, s53, v22
    v_lshl_add_u32 v5, v22, 6, v21
    v_xor_b32 v22, 1, v22
    v_lshl_add_u32 v6, v22, 6, v21
    s_mul_i32 s54, s53, 28672
    v_add_u32 v5, s54, v5
    v_add_u32 v6, s54, v6
    s_lshl_b32 s50, s44, 1
    s_add_u32 s50, s50, s53
    s_and_b32 s53, s40, 1
    s_lshl_b32 s49, s43, 1
    s_add_u32 s49, s49, s53
    s_and_b32 s53, s40, 3
    s_lshl_b32 s87, s53, 7
    s_lshl_b32 s48, s41, 2
    s_add_u32 s48, s48, s53
    s_waitcnt lgkmcnt(0)
    s_mov_b32 s8, s64
    s_mov_b32 s9, s65
    s_mov_b32 s10, 1835008
    s_mov_b32 s11, 0x20000
    s_mov_b32 s12, s66
    s_mov_b32 s13, s67
    s_mov_b32 s14, 1204224
    s_mov_b32 s15, 0x20000
    s_mov_b32 s16, s68
    s_mov_b32 s17, s69
    s_mov_b32 s18, 401408
    s_mov_b32 s19, 0x20000
    s_mov_b32 s20, s76
    s_mov_b32 s21, s77
    s_mov_b32 s22, 1835008
    s_mov_b32 s23, 0x20000
    s_mov_b32 s24, s78
    s_mov_b32 s25, s79
    s_mov_b32 s26, 256
    s_mov_b32 s27, 0x20000
    s_mov_b32 s28, s80
    s_mov_b32 s29, s81
    s_mov_b32 s30, 268435456
    s_mov_b32 s31, 0x20000
    s_mov_b32 s32, s80
    s_mov_b32 s33, s81
    s_mov_b32 s34, 268435456
    s_mov_b32 s35, 0x20000
    s_cmp_lt_u32 s40, 4
    s_cbranch_scc1 L_layerA
    s_sub_u32 s86, s40, 4
    v_lshrrev_b32 v22, 3, v1
    v_and_b32 v23, 7, v1
    v_bfe_u32 v28, v1, 4, 1
    v_lshlrev_b32 v28, 2, v28
    v_xor_b32 v23, v23, v28
    v_mul_u32_u24 v29, 896, v22
    v_lshl_add_u32 v18, v23, 4, v29
    v_mul_u32_u24 v29, 2688, v22
    v_lshrrev_b32 v28, 2, v23
    v_mul_u32_u24 v28, 896, v28
    v_and_b32 v23, 3, v23
    v_lshl_add_u32 v29, v23, 4, v29
    v_add_u32 v16, v29, v28
    v_lshrrev_b32 v22, 2, v1
    v_mul_u32_u24 v22, 2688, v22
    v_lshl_add_u32 v17, v23, 4, v22
    s_mul_i32 s58, s42, 56
    s_and_b32 s58, s58, 0xfff0
    s_mul_i32 s54, s86, 21504
    s_add_u32 s54, s54, s58
    s_add_u32 s98, s54, 896
    s_add_u32 s99, s98, 1204224
    s_mul_i32 s97, s84, 172032
    s_add_u32 s54, s98, s97
    s_lshl_b32 s53, s86, 10
    v_mov_b32 v28, 0
    v_mov_b32 v29, 0
    v_mov_b32 v30, 0
    v_mov_b32 v31, 0
    s_cmp_lg_u32 s86, 3
    s_cbranch_scc1 L_h_noz
    s_cmp_ge_u32 s2, 24
    s_cbranch_scc1 L_h_noz
    v_mul_u32_u24 v22, 128, v1
    s_mul_i32 s55, s2, 8192
    buffer_store_dwordx4 v[28:31], v22, s[28:31], s55 offen sc1
    buffer_store_dwordx4 v[28:31], v22, s[28:31], s55 offen offset:16 sc1
    buffer_store_dwordx4 v[28:31], v22, s[28:31], s55 offen offset:32 sc1
    buffer_store_dwordx4 v[28:31], v22, s[28:31], s55 offen offset:48 sc1
L_h_noz:
    s_mov_b32 m0, s53
    s_add_u32 s53, s53, 4096
    buffer_load_dwordx4 v16, s[12:15], s54 offen lds
    s_add_u32 s54, s54, 86016
    s_cmp_eq_u32 s54, s99
    s_cselect_b32 s54, s98, s54
    s_mov_b32 m0, s53
    s_add_u32 s53, s53, 4096
    buffer_load_dwordx4 v16, s[12:15], s54 offen lds
    s_add_u32 s54, s54, 86016
    s_cmp_eq_u32 s54, s99
    s_cselect_b32 s54, s98, s54
    s_mov_b32 m0, s53
    s_add_u32 s53, s53, 4096
    buffer_load_dwordx4 v16, s[12:15], s54 offen lds
    s_add_u32 s54, s54, 86016
    s_cmp_eq_u32 s54, s99
    s_cselect_b32 s54, s98, s54
    s_mov_b32 m0, s53
    s_add_u32 s53, s53, 4096
    buffer_load_dwordx4 v16, s[12:15], s54 offen lds
    s_add_u32 s54, s54, 86016
    s_cmp_eq_u32 s54, s99
    s_cselect_b32 s54, s98, s54
    s_mov_b32 m0, s53
    s_add_u32 s53, s53, 4096
    buffer_load_dwordx4 v16, s[12:15], s54 offen lds
    s_add_u32 s54, s54, 86016
    s_cmp_eq_u32 s54, s99
    s_cselect_b32 s54, s98, s54
    s_mov_b32 m0, s53
    s_add_u32 s53, s53, 4096
    buffer_load_dwordx4 v16, s[12:15], s54 offen lds
    s_add_u32 s54, s54, 86016
    s_cmp_eq_u32 s54, s99
    s_cselect_b32 s54, s98, s54
    s_mov_b32 m0, s53
    s_add_u32 s53, s53, 4096
    buffer_load_dwordx4 v16, s[12:15], s54 offen lds
    s_add_u32 s54, s54, 86016
    s_cmp_eq_u32 s54, s99
    s_cselect_b32 s54, s98, s54
    s_mov_b32 m0, s53
    s_add_u32 s53, s53, 4096
    buffer_load_dwordx4 v16, s[12:15], s54 offen lds
    s_add_u32 s54, s54, 86016
    s_cmp_eq_u32 s54, s99
    s_cselect_b32 s54, s98, s54
    s_mov_b32 m0, s53
    s_add_u32 s53, s53, 4096
    buffer_load_dwordx4 v16, s[12:15], s54 offen lds
    s_add_u32 s54, s54, 86016
    s_cmp_eq_u32 s54, s99
    s_cselect_b32 s54, s98, s54
    s_mov_b32 m0, s53
    s_add_u32 s53, s53, 4096
    buffer_load_dwordx4 v16, s[12:15], s54 offen lds
    s_add_u32 s54, s54, 86016
    s_cmp_eq_u32 s54, s99
    s_cselect_b32 s54, s98, s54
    s_mov_b32 m0, s53
    s_add_u32 s53, s53, 4096
    buffer_load_dwordx4 v16, s[12:15], s54 offen lds
    s_add_u32 s54, s54, 86016
    s_cmp_eq_u32 s54, s99
    s_cselect_b32 s54, s98, s54
    s_mov_b32 m0, s53
    s_add_u32 s53, s53, 4096
    buffer_load_dwordx4 v16, s[12:15], s54 offen lds
    s_add_u32 s54, s54, 86016
    s_cmp_eq_u32 s54, s99
    s_cselect_b32 s54, s98, s54
    s_mov_b32 m0, s53
    s_add_u32 s53, s53, 4096
    buffer_load_dwordx4 v16, s[12:15], s54 offen lds
    s_add_u32 s54, s54, 86016
    s_cmp_eq_u32 s54, s99
    s_cselect_b32 s54, s98, s54
    s_mov_b32 m0, s53
    s_add_u32 s53, s53, 4096
    buffer_load_dwordx4 v16, s[12:15], s54 offen lds
    s_add_u32 s54, s54, 86016
    s_cmp_eq_u32 s54, s99
    s_cselect_b32 s54, s98, s54
    v_and_b32 v22, 31, v1
    v_lshlrev_b32 v19, 2, v22
    v_mov_b32 v24, 0x3f803f80
    v_mov_b32 v25, 0x3f803f80
    v_mov_b32 v26, 0x3f803f80
    v_mov_b32 v27, 0x3f803f80
    v_mov_b32 v128, -1
    v_mov_b32 v129, -1
    v_mov_b32 v130, -1
    v_mov_b32 v131, -1
    v_mov_b32 v132, 1
    v_and_b32 v22, 15, v1
    v_lshlrev_b32 v22, 2, v22
    v_add_u32 v22, 163584, v22
    ds_write_b32 v22, v28
    s_and_b32 s55, s86, 1
    s_lshl_b32 s55, s55, 12
    s_cmp_ge_u32 s86, 2
    s_cselect_b64 vcc, -1, 0
    v_cndmask_b32 v20, v3, v4, vcc
    v_add_u32 v20, s55, v20
    s_mul_i32 s56, s86, 43008
    s_add_u32 s56, s56, s58
    s_add_u32 s100, s56, 1204224
    s_add_u32 s57, s56, s97
    s_lshl_b32 s85, s86, 10
    s_add_u32 s85, s85, 57344
    s_waitcnt lgkmcnt(0)
    s_setprio 1
    s_waitcnt vmcnt(10)
    s_cmp_lg_u32 s86, 3
    s_cbranch_scc1 L_h_nosig
    s_cmp_ge_u32 s2, 24
    s_cbranch_scc1 L_h_nosig
    s_mov_b64 exec, 1
    buffer_atomic_add v132, off, s[24:27], 0 sc1
    s_mov_b64 exec, -1
L_h_nosig:
    s_barrier
    ds_read_b64_tr_b16 v[28:29], v20 offset:0
    ds_read_b64_tr_b16 v[30:31], v20 offset:512
    ds_read_b64_tr_b16 v[32:33], v20 offset:2048
    ds_read_b64_tr_b16 v[34:35], v20 offset:2560
    ds_read_b64_tr_b16 v[36:37], v20 offset:8192
    ds_read_b64_tr_b16 v[38:39], v20 offset:8704
    ds_read_b64_tr_b16 v[40:41], v20 offset:10240
    ds_read_b64_tr_b16 v[42:43], v20 offset:10752
    s_waitcnt lgkmcnt(0)
    v_mfma_f32_32x32x16_bf16 v[80:95], v[24:27], v[28:31], 0
    v_mfma_f32_32x32x16_bf16 v[80:95], v[24:27], v[32:35], v[80:95]
    v_mfma_f32_32x32x16_bf16 v[80:95], v[24:27], v[36:39], v[80:95]
    v_mfma_f32_32x32x16_bf16 v[80:95], v[24:27], v[40:43], v[80:95]
    s_mov_b32 m0, s85
    s_add_u32 s85, s85, 4096
    buffer_load_dwordx4 v17, s[12:15], s57 offen lds
    s_add_u32 s57, s57, 172032
    s_cmp_eq_u32 s57, s100
    s_cselect_b32 s57, s56, s57
    s_mov_b32 m0, s85
    s_add_u32 s85, s85, 4096
    buffer_load_dwordx4 v17, s[12:15], s57 offen lds
    s_add_u32 s57, s57, 172032
    s_cmp_eq_u32 s57, s100
    s_cselect_b32 s57, s56, s57
    s_mov_b32 m0, s85
    s_add_u32 s85, s85, 4096
    buffer_load_dwordx4 v17, s[12:15], s57 offen lds
    s_add_u32 s57, s57, 172032
    s_cmp_eq_u32 s57, s100
    s_cselect_b32 s57, s56, s57
    s_mov_b32 m0, s85
    s_add_u32 s85, s85, 4096
    buffer_load_dwordx4 v17, s[12:15], s57 offen lds
    s_add_u32 s57, s57, 172032
    s_cmp_eq_u32 s57, s100
    s_cselect_b32 s57, s56, s57
    s_waitcnt vmcnt(10)
    s_barrier
    ds_read_b64_tr_b16 v[28:29], v20 offset:16384
    ds_read_b64_tr_b16 v[30:31], v20 offset:16896
    ds_read_b64_tr_b16 v[32:33], v20 offset:18432
    ds_read_b64_tr_b16 v[34:35], v20 offset:18944
    ds_read_b64_tr_b16 v[36:37], v20 offset:24576
    ds_read_b64_tr_b16 v[38:39], v20 offset:25088
    ds_read_b64_tr_b16 v[40:41], v20 offset:26624
    ds_read_b64_tr_b16 v[42:43], v20 offset:27136
    s_waitcnt lgkmcnt(0)
    v_mfma_f32_32x32x16_bf16 v[80:95], v[24:27], v[28:31], v[80:95]
    v_mfma_f32_32x32x16_bf16 v[80:95], v[24:27], v[32:35], v[80:95]
    v_mfma_f32_32x32x16_bf16 v[80:95], v[24:27], v[36:39], v[80:95]
    v_mfma_f32_32x32x16_bf16 v[80:95], v[24:27], v[40:43], v[80:95]
    s_mov_b32 m0, s85
    s_add_u32 s85, s85, 4096
    buffer_load_dwordx4 v17, s[12:15], s57 offen lds
    s_add_u32 s57, s57, 172032
    s_cmp_eq_u32 s57, s100
    s_cselect_b32 s57, s56, s57
    s_mov_b32 m0, s85
    s_add_u32 s85, s85, 4096
    buffer_load_dwordx4 v17, s[12:15], s57 offen lds
    s_add_u32 s57, s57, 172032
    s_cmp_eq_u32 s57, s100
    s_cselect_b32 s57, s56, s57
    s_mov_b32 m0, s85
    s_add_u32 s85, s85, 4096
    buffer_load_dwordx4 v17, s[12:15], s57 offen lds
    s_add_u32 s57, s57, 172032
    s_cmp_eq_u32 s57, s100
    s_cselect_b32 s57, s56, s57
    s_waitcnt vmcnt(7)
    s_barrier
    ds_read_b64_tr_b16 v[28:29], v20 offset:32768
    ds_read_b64_tr_b16 v[30:31], v20 offset:33280
    ds_read_b64_tr_b16 v[32:33], v20 offset:34816
    ds_read_b64_tr_b16 v[34:35], v20 offset:35328
    ds_read_b64_tr_b16 v[36:37], v20 offset:40960
    ds_read_b64_tr_b16 v[38:39], v20 offset:41472
    ds_read_b64_tr_b16 v[40:41], v20 offset:43008
    ds_read_b64_tr_b16 v[42:43], v20 offset:43520
    ds_read_b64_tr_b16 v[44:45], v20 offset:49152
    ds_read_b64_tr_b16 v[46:47], v20 offset:49664
    ds_read_b64_tr_b16 v[48:49], v20 offset:51200
    ds_read_b64_tr_b16 v[50:51], v20 offset:51712
    s_waitcnt lgkmcnt(0)
    v_mfma_f32_32x32x16_bf16 v[80:95], v[24:27], v[28:31], v[80:95]
    v_mfma_f32_32x32x16_bf16 v[80:95], v[24:27], v[32:35], v[80:95]
    v_mfma_f32_32x32x16_bf16 v[80:95], v[24:27], v[36:39], v[80:95]
    v_mfma_f32_32x32x16_bf16 v[80:95], v[24:27], v[40:43], v[80:95]
    v_mfma_f32_32x32x16_bf16 v[80:95], v[24:27], v[44:47], v[80:95]
    v_mfma_f32_32x32x16_bf16 v[80:95], v[24:27], v[48:51], v[80:95]
    s_and_b32 s55, s86, 1
    s_lshl_b32 s55, s55, 8
    s_lshr_b32 s82, s86, 1
    s_lshl_b32 s82, s82, 7
    s_add_u32 s55, s55, s82
    s_add_u32 s55, s55, 160768
    v_add_u32 v22, s55, v19
    s_nop 4
    ds_write_b32 v22, v80 offset:0
    s_waitcnt lgkmcnt(0)
    s_setprio 0
    s_barrier
    s_lshr_b32 s53, s86, 1
    s_cmp_eq_u32 s53, 0
    s_cselect_b32 s12, s66, s72
    s_cselect_b32 s13, s67, s73
    s_lshl_b32 s53, s53, 4
    s_add_u32 s53, s53, s42
    s_mul_i32 s57, s53, 86016
    s_add_u32 s57, s57, 0x00400000
    s_mul_i32 s54, s41, 75264
    s_add_u32 s54, s54, s58
    s_bitcmp1_b32 s86, 0
    s_cbranch_scc1 L_h_packq
    s_add_u32 s54, s54, 896
    s_mul_i32 s55, s41, 3584
    s_add_u32 s57, s57, s55
    buffer_load_dwordx4 v[112:115], v16, s[12:15], s54 offen
    s_add_u32 s54, s54, 21504
    buffer_load_dwordx4 v[116:119], v16, s[12:15], s54 offen
    s_add_u32 s54, s54, 21504
    buffer_load_dwordx4 v[120:123], v16, s[12:15], s54 offen
    s_add_u32 s54, s54, 21504
    buffer_load_dwordx4 v[124:127], v16, s[12:15], s54 offen
    s_add_u32 s54, s54, 21504
    s_waitcnt vmcnt(4)
    s_branch L_h_packed
L_h_packq:
    s_mul_i32 s55, s41, 1792
    s_add_u32 s57, s57, s55
    s_add_u32 s57, s57, 57344
    buffer_load_dwordx4 v[112:115], v17, s[12:15], s54 offen
    s_add_u32 s54, s54, 43008
    buffer_load_dwordx4 v[116:119], v17, s[12:15], s54 offen
    s_waitcnt vmcnt(2)
L_h_packed:
    s_lshl_b32 s55, s86, 10
    v_add_u32 v20, s55, v8
    ds_read_b64_tr_b16 v[28:29], v20 offset:0
    ds_read_b64_tr_b16 v[30:31], v20 offset:256
    ds_read_b64_tr_b16 v[32:33], v20 offset:4096
    ds_read_b64_tr_b16 v[34:35], v20 offset:4352
    ds_read_b64_tr_b16 v[36:37], v20 offset:8192
    ds_read_b64_tr_b16 v[38:39], v20 offset:8448
    ds_read_b64_tr_b16 v[40:41], v20 offset:12288
    ds_read_b64_tr_b16 v[42:43], v20 offset:12544
    ds_read_b64_tr_b16 v[44:45], v20 offset:16384
    ds_read_b64_tr_b16 v[46:47], v20 offset:16640
    ds_read_b64_tr_b16 v[48:49], v20 offset:20480
    ds_read_b64_tr_b16 v[50:51], v20 offset:20736
    ds_read_b64_tr_b16 v[52:53], v20 offset:24576
    ds_read_b64_tr_b16 v[54:55], v20 offset:24832
    s_waitcnt lgkmcnt(12)
    v_mfma_f32_32x32x16_bf16 v[64:79], v[24:27], v[28:31], 0
    s_waitcnt lgkmcnt(10)
    v_mfma_f32_32x32x16_bf16 v[64:79], v[24:27], v[32:35], v[64:79]
    s_waitcnt lgkmcnt(8)
    v_mfma_f32_32x32x16_bf16 v[64:79], v[24:27], v[36:39], v[64:79]
    s_waitcnt lgkmcnt(6)
    v_mfma_f32_32x32x16_bf16 v[64:79], v[24:27], v[40:43], v[64:79]
    s_waitcnt lgkmcnt(4)
    v_mfma_f32_32x32x16_bf16 v[64:79], v[24:27], v[44:47], v[64:79]
    s_waitcnt lgkmcnt(2)
    v_mfma_f32_32x32x16_bf16 v[64:79], v[24:27], v[48:51], v[64:79]
    s_waitcnt lgkmcnt(0)
    v_mfma_f32_32x32x16_bf16 v[64:79], v[24:27], v[52:55], v[64:79]
    s_cmp_lg_u32 s86, 0
    s_cbranch_scc1 Lr1_1
    s_mov_b32 s52, 200000
    s_mov_b64 exec, 1
Lpc_3:
    v_mov_b32 v22, 0
    buffer_load_dword v22, off, s[24:27], 0  sc1
    s_waitcnt vmcnt(0)
    v_cmp_gt_u32 vcc, 24, v22
    s_nop 1
    s_cbranch_vccz Lpd_4
    s_sub_u32 s52, s52, 1
    s_cmp_eq_u32 s52, 0
    s_cbranch_scc0 Lpc_3
    s_endpgm
Lpd_4:
    s_mov_b64 exec, -1
    s_branch Lrd_2
Lr1_1:
    s_add_u32 s56, s86, -1
    s_lshl_b32 s55, s44, 7
    s_min_u32 s53, s56, 56
    s_mul_i32 s54, s53, 7168
    s_add_u32 s54, s54, s55
    s_lshl_b32 s53, s53, 10
    s_add_u32 m0, s53, 86016
    s_add_u32 s56, s56, 3
    buffer_load_dwordx4 v18, s[16:19], s54 offen lds
    s_min_u32 s53, s56, 56
    s_mul_i32 s54, s53, 7168
    s_add_u32 s54, s54, s55
    s_lshl_b32 s53, s53, 10
    s_add_u32 m0, s53, 86016
    s_add_u32 s56, s56, 3
    buffer_load_dwordx4 v18, s[16:19], s54 offen lds
    s_min_u32 s53, s56, 56
    s_mul_i32 s54, s53, 7168
    s_add_u32 s54, s54, s55
    s_lshl_b32 s53, s53, 10
    s_add_u32 m0, s53, 86016
    s_add_u32 s56, s56, 3
    buffer_load_dwordx4 v18, s[16:19], s54 offen lds
    s_min_u32 s53, s56, 56
    s_mul_i32 s54, s53, 7168
    s_add_u32 s54, s54, s55
    s_lshl_b32 s53, s53, 10
    s_add_u32 m0, s53, 86016
    s_add_u32 s56, s56, 3
    buffer_load_dwordx4 v18, s[16:19], s54 offen lds
    s_min_u32 s53, s56, 56
    s_mul_i32 s54, s53, 7168
    s_add_u32 s54, s54, s55
    s_lshl_b32 s53, s53, 10
    s_add_u32 m0, s53, 86016
    s_add_u32 s56, s56, 3
    buffer_load_dwordx4 v18, s[16:19], s54 offen lds
    s_min_u32 s53, s56, 56
    s_mul_i32 s54, s53, 7168
    s_add_u32 s54, s54, s55
    s_lshl_b32 s53, s53, 10
    s_add_u32 m0, s53, 86016
    s_add_u32 s56, s56, 3
    buffer_load_dwordx4 v18, s[16:19], s54 offen lds
    s_min_u32 s53, s56, 56
    s_mul_i32 s54, s53, 7168
    s_add_u32 s54, s54, s55
    s_lshl_b32 s53, s53, 10
    s_add_u32 m0, s53, 86016
    s_add_u32 s56, s56, 3
    buffer_load_dwordx4 v18, s[16:19], s54 offen lds
Lrd_2:
    s_lshl_b32 s55, s86, 7
    s_add_u32 s55, s55, 161280
    v_add_u32 v22, s55, v19
    ds_write_b32 v22, v64 offset:0
    s_waitcnt lgkmcnt(0)
    s_barrier
    s_cmp_lg_u32 s86, 0
    s_cbranch_scc1 Lr1_5
    s_add_u32 s53, s3, 0x00000000
    s_mov_b32 s52, 200000
    s_mov_b64 exec, 1
Lpc_8:
    v_mov_b32 v22, 0
    buffer_atomic_add v22, off, s[28:31], s53  sc0 sc1
    s_waitcnt vmcnt(0)
    v_cmp_gt_u32 vcc, 16, v22
    s_nop 1
    s_cbranch_vccz Lpd_9
    s_sub_u32 s52, s52, 1
    s_cmp_eq_u32 s52, 0
    s_cbranch_scc0 Lpc_8
    s_endpgm
Lpd_9:
    s_mov_b64 exec, -1
Lps_7:
    s_branch Lrd_6
Lr1_5:
    s_cmp_lg_u32 s86, 1
    s_cbranch_scc1 Lsk_10
    s_add_u32 s53, s3, 0x00000000
    s_mov_b64 exec, 1
    buffer_atomic_add v132, off, s[28:31], s53 sc1
    s_mov_b64 exec, -1
Lsk_10:
    s_and_b32 s55, s42, 1
    s_mul_i32 s55, s55, 3
    s_xor_b32 s55, s55, 3
    v_and_b32 v22, 3, v1
    v_cmp_ne_u32 vcc, s55, v22
    s_waitcnt vmcnt(7)
    s_bitcmp1_b32 s42, 0
    s_cbranch_scc1 Lzo_11
    v_cndmask_b32 v114, 0, v114, vcc
    v_cndmask_b32 v115, 0, v115, vcc
    v_cndmask_b32 v118, 0, v118, vcc
    v_cndmask_b32 v119, 0, v119, vcc
    v_cndmask_b32 v122, 0, v122, vcc
    v_cndmask_b32 v123, 0, v123, vcc
    v_cndmask_b32 v126, 0, v126, vcc
    v_cndmask_b32 v127, 0, v127, vcc
    s_branch Lzd_12
Lzo_11:
    v_cndmask_b32 v112, 0, v112, vcc
    v_cndmask_b32 v113, 0, v113, vcc
    v_cndmask_b32 v116, 0, v116, vcc
    v_cndmask_b32 v117, 0, v117, vcc
    v_cndmask_b32 v120, 0, v120, vcc
    v_cndmask_b32 v121, 0, v121, vcc
    v_cndmask_b32 v124, 0, v124, vcc
    v_cndmask_b32 v125, 0, v125, vcc
Lzd_12:
    buffer_store_dwordx4 v[112:115], v2, s[28:31], s57 offen sc1
    s_bitcmp1_b32 s86, 0
    s_cbranch_scc1 Lsq_13
    buffer_store_dwordx4 v[116:119], v2, s[28:31], s57 offen offset:1024 sc1
    buffer_store_dwordx4 v[120:123], v2, s[28:31], s57 offen offset:2048 sc1
    s_mov_b32 exec_hi, 0
    buffer_store_dwordx4 v[124:127], v2, s[28:31], s57 offen offset:3072 sc1
    s_branch Lsd_14
Lsq_13:
    s_mov_b32 exec_hi, 0xffff
    buffer_store_dwordx4 v[116:119], v2, s[28:31], s57 offen offset:1024 sc1
Lsd_14:
    s_mov_b64 exec, -1
    s_add_u32 s56, s86, 20
    s_lshl_b32 s55, s44, 7
    s_min_u32 s53, s56, 56
    s_mul_i32 s54, s53, 7168
    s_add_u32 s54, s54, s55
    s_lshl_b32 s53, s53, 10
    s_add_u32 m0, s53, 86016
    s_add_u32 s56, s56, 3
    buffer_load_dwordx4 v18, s[16:19], s54 offen lds
    s_min_u32 s53, s56, 56
    s_mul_i32 s54, s53, 7168
    s_add_u32 s54, s54, s55
    s_lshl_b32 s53, s53, 10
    s_add_u32 m0, s53, 86016
    s_add_u32 s56, s56, 3
    buffer_load_dwordx4 v18, s[16:19], s54 offen lds
    s_min_u32 s53, s56, 56
    s_mul_i32 s54, s53, 7168
    s_add_u32 s54, s54, s55
    s_lshl_b32 s53, s53, 10
    s_add_u32 m0, s53, 86016
    s_add_u32 s56, s56, 3
    buffer_load_dwordx4 v18, s[16:19], s54 offen lds
    s_min_u32 s53, s56, 56
    s_mul_i32 s54, s53, 7168
    s_add_u32 s54, s54, s55
    s_lshl_b32 s53, s53, 10
    s_add_u32 m0, s53, 86016
    s_add_u32 s56, s56, 3
    buffer_load_dwordx4 v18, s[16:19], s54 offen lds
    s_min_u32 s53, s56, 56
    s_mul_i32 s54, s53, 7168
    s_add_u32 s54, s54, s55
    s_lshl_b32 s53, s53, 10
    s_add_u32 m0, s53, 86016
    s_add_u32 s56, s56, 3
    buffer_load_dwordx4 v18, s[16:19], s54 offen lds
    s_min_u32 s53, s56, 56
    s_mul_i32 s54, s53, 7168
    s_add_u32 s54, s54, s55
    s_lshl_b32 s53, s53, 10
    s_add_u32 m0, s53, 86016
    s_add_u32 s56, s56, 3
    buffer_load_dwordx4 v18, s[16:19], s54 offen lds
    s_min_u32 s53, s56, 56
    s_mul_i32 s54, s53, 7168
    s_add_u32 s54, s54, s55
    s_lshl_b32 s53, s53, 10
    s_add_u32 m0, s53, 86016
    s_add_u32 s56, s56, 3
    buffer_load_dwordx4 v18, s[16:19], s54 offen lds
    s_cmp_eq_u32 s86, 1
    s_cbranch_scc1 Lrd_6
    s_waitcnt vmcnt(7)
    s_add_u32 s53, s3, 0x00016000
    s_mov_b64 exec, 1
    buffer_atomic_add v132, off, s[28:31], s53 sc1
    s_mov_b64 exec, -1
Lrd_6:
    s_barrier
    s_cmp_lg_u32 s86, 0
    s_cbranch_scc1 Lr1_15
    s_add_u32 s56, s3, 0x00016000
    s_mov_b32 s52, 200000
    s_mov_b64 exec, 1
Lpc_17:
    v_mov_b32 v22, 0
    buffer_atomic_add v22, off, s[28:31], s56  sc0 sc1
    s_waitcnt vmcnt(0)
    v_cmp_gt_u32 vcc, 32, v22
    s_nop 1
    s_cbranch_vccz Lpd_18
    s_sub_u32 s52, s52, 1
    s_cmp_eq_u32 s52, 0
    s_cbranch_scc0 Lpc_17
    s_endpgm
Lpd_18:
    s_mov_b64 exec, -1
    s_and_b32 s55, s42, 1
    s_mul_i32 s55, s55, 3
    s_xor_b32 s55, s55, 3
    v_and_b32 v22, 3, v1
    v_cmp_ne_u32 vcc, s55, v22
    s_waitcnt vmcnt(0)
    s_bitcmp1_b32 s42, 0
    s_cbranch_scc1 Lzo_19
    v_cndmask_b32 v114, 0, v114, vcc
    v_cndmask_b32 v115, 0, v115, vcc
    v_cndmask_b32 v118, 0, v118, vcc
    v_cndmask_b32 v119, 0, v119, vcc
    v_cndmask_b32 v122, 0, v122, vcc
    v_cndmask_b32 v123, 0, v123, vcc
    v_cndmask_b32 v126, 0, v126, vcc
    v_cndmask_b32 v127, 0, v127, vcc
    s_branch Lzd_20
Lzo_19:
    v_cndmask_b32 v112, 0, v112, vcc
    v_cndmask_b32 v113, 0, v113, vcc
    v_cndmask_b32 v116, 0, v116, vcc
    v_cndmask_b32 v117, 0, v117, vcc
    v_cndmask_b32 v120, 0, v120, vcc
    v_cndmask_b32 v121, 0, v121, vcc
    v_cndmask_b32 v124, 0, v124, vcc
    v_cndmask_b32 v125, 0, v125, vcc
Lzd_20:
    buffer_store_dwordx4 v[112:115], v2, s[28:31], s57 offen sc1
    s_bitcmp1_b32 s86, 0
    s_cbranch_scc1 Lsq_21
    buffer_store_dwordx4 v[116:119], v2, s[28:31], s57 offen offset:1024 sc1
    buffer_store_dwordx4 v[120:123], v2, s[28:31], s57 offen offset:2048 sc1
    s_mov_b32 exec_hi, 0
    buffer_store_dwordx4 v[124:127], v2, s[28:31], s57 offen offset:3072 sc1
    s_branch Lsd_22
Lsq_21:
    s_mov_b32 exec_hi, 0xffff
    buffer_store_dwordx4 v[116:119], v2, s[28:31], s57 offen offset:1024 sc1
Lsd_22:
    s_mov_b64 exec, -1
    s_branch Lrd_16
Lr1_15:
    s_add_u32 s56, s86, 41
    s_lshl_b32 s55, s44, 7
    s_min_u32 s53, s56, 56
    s_mul_i32 s54, s53, 7168
    s_add_u32 s54, s54, s55
    s_lshl_b32 s53, s53, 10
    s_add_u32 m0, s53, 86016
    s_add_u32 s56, s56, 3
    buffer_load_dwordx4 v18, s[16:19], s54 offen lds
    s_min_u32 s53, s56, 56
    s_mul_i32 s54, s53, 7168
    s_add_u32 s54, s54, s55
    s_lshl_b32 s53, s53, 10
    s_add_u32 m0, s53, 86016
    s_add_u32 s56, s56, 3
    buffer_load_dwordx4 v18, s[16:19], s54 offen lds
    s_min_u32 s53, s56, 56
    s_mul_i32 s54, s53, 7168
    s_add_u32 s54, s54, s55
    s_lshl_b32 s53, s53, 10
    s_add_u32 m0, s53, 86016
    s_add_u32 s56, s56, 3
    buffer_load_dwordx4 v18, s[16:19], s54 offen lds
    s_min_u32 s53, s56, 56
    s_mul_i32 s54, s53, 7168
    s_add_u32 s54, s54, s55
    s_lshl_b32 s53, s53, 10
    s_add_u32 m0, s53, 86016
    s_add_u32 s56, s56, 3
    buffer_load_dwordx4 v18, s[16:19], s54 offen lds
    s_min_u32 s53, s56, 56
    s_mul_i32 s54, s53, 7168
    s_add_u32 s54, s54, s55
    s_lshl_b32 s53, s53, 10
    s_add_u32 m0, s53, 86016
    s_add_u32 s56, s56, 3
    buffer_load_dwordx4 v18, s[16:19], s54 offen lds
Lrd_16:
    s_barrier
    s_cmp_lg_u32 s86, 0
    s_cbranch_scc1 Lr1_23
    s_branch Lrd_24
Lr1_23:
    s_add_u32 s54, s42, 16
    s_mul_i32 s54, s54, 86016
    s_add_u32 s54, s54, 0x00400000
    s_sub_u32 s53, s86, 1
    s_lshl_b32 s53, s53, 10
    s_mov_b32 m0, s53
    s_add_u32 s55, s53, s54
    s_add_u32 s53, s53, 3072
    buffer_load_dwordx4 v2, s[28:31], s55 offen sc1 lds
    s_mov_b32 m0, s53
    s_add_u32 s55, s53, s54
    s_add_u32 s53, s53, 3072
    buffer_load_dwordx4 v2, s[28:31], s55 offen sc1 lds
    s_mov_b32 m0, s53
    s_add_u32 s55, s53, s54
    s_add_u32 s53, s53, 3072
    buffer_load_dwordx4 v2, s[28:31], s55 offen sc1 lds
    s_mov_b32 m0, s53
    s_add_u32 s55, s53, s54
    s_add_u32 s53, s53, 3072
    buffer_load_dwordx4 v2, s[28:31], s55 offen sc1 lds
    s_mov_b32 m0, s53
    s_add_u32 s55, s53, s54
    s_add_u32 s53, s53, 3072
    buffer_load_dwordx4 v2, s[28:31], s55 offen sc1 lds
    s_mov_b32 m0, s53
    s_add_u32 s55, s53, s54
    s_add_u32 s53, s53, 3072
    buffer_load_dwordx4 v2, s[28:31], s55 offen sc1 lds
    s_mov_b32 m0, s53
    s_add_u32 s55, s53, s54
    s_add_u32 s53, s53, 3072
    buffer_load_dwordx4 v2, s[28:31], s55 offen sc1 lds
    s_waitcnt vmcnt(7)
Lrd_24:
    s_barrier
    s_cmp_ge_u32 s86, 2
    s_cbranch_scc1 Lr2_26
    s_cmp_eq_u32 s86, 1
    s_cbranch_scc1 Lr1_25
    s_cmp_eq_u32 s45, 0
    s_cbranch_scc1 Lps_28
    s_add_u32 s53, s5, 0x00002000
    s_mov_b32 s52, 200000
    s_mov_b64 exec, 1
Lpc_29:
    v_mov_b32 v22, 0
    buffer_atomic_add v22, off, s[28:31], s53  sc0 sc1
    s_waitcnt vmcnt(0)
    v_cmp_gt_u32 vcc, 16, v22
    s_nop 1
    s_cbranch_vccz Lpd_30
    s_sub_u32 s52, s52, 1
    s_cmp_eq_u32 s52, 0
    s_cbranch_scc0 Lpc_29
    s_endpgm
Lpd_30:
    s_mov_b64 exec, -1
    v_mov_b32 v20, 163588
    s_mov_b64 exec, 1
    ds_write_b32 v20, v22
    s_mov_b64 exec, -1
    s_waitcnt lgkmcnt(0)
Lps_28:
    s_branch Lrd_27
Lr1_25:
    s_add_u32 s53, s4, 0x00002000
    s_mov_b64 exec, 1
    buffer_atomic_add v132, off, s[28:31], s53 sc1
    s_mov_b64 exec, -1
    s_branch Lrd_27
Lr2_26:
    s_add_u32 s54, s42, 16
    s_mul_i32 s54, s54, 86016
    s_add_u32 s54, s54, 0x00400000
    s_and_b32 s53, s86, 1
    s_lshl_b32 s53, s53, 10
    s_add_u32 s53, s53, 21504
Lhq_31:
    s_mov_b32 m0, s53
    s_add_u32 s55, s53, s54
    buffer_load_dwordx4 v2, s[28:31], s55 offen sc1 lds
    s_add_u32 s53, s53, 2048
    s_cmp_lt_u32 s53, 57344
    s_cbranch_scc1 Lhq_31
Lrd_27:
    s_barrier
    s_cmp_eq_u32 s45, 0
    s_cbranch_scc1 Lpf_32
    s_mul_i32 s55, s49, 14
    s_add_u32 s55, s55, s50
    s_lshl_b32 s82, s55, 11
    s_add_u32 s82, s82, 0x01000000
    s_lshl_b32 s55, s55, 8
    s_add_u32 s55, s55, 0x01800000
    buffer_store_dwordx4 v[128:131], v2, s[28:31], s82 offen offset:0 sc1
    buffer_store_dwordx4 v[128:131], v2, s[28:31], s82 offen offset:1024 sc1
    s_mov_b64 exec, 0xffff
    buffer_store_dwordx4 v[128:131], v2, s[28:31], s55 offen offset:0 sc1
    s_mov_b64 exec, -1
Lpf_32:
    s_lshl_b32 s55, s48, 4
    s_add_u32 s55, s55, s42
    s_lshl_b32 s55, s55, 11
    s_add_u32 s55, s55, 0x02200000
    buffer_store_dwordx4 v[128:131], v2, s[28:31], s55 offen offset:0 sc1
    buffer_store_dwordx4 v[128:131], v2, s[28:31], s55 offen offset:1024 sc1
    s_lshl_b32 s55, s42, 6
    s_add_u32 s55, s55, s48
    s_lshl_b32 s55, s55, 12
    s_add_u32 s55, s55, 0x02400000
    buffer_store_dwordx4 v[128:131], v2, s[28:31], s55 offen offset:0 sc1
    buffer_store_dwordx4 v[128:131], v2, s[28:31], s55 offen offset:1024 sc1
    buffer_store_dwordx4 v[128:131], v2, s[28:31], s55 offen offset:2048 sc1
    buffer_store_dwordx4 v[128:131], v2, s[28:31], s55 offen offset:3072 sc1
    s_waitcnt vmcnt(6)
    s_barrier
    s_cmp_ge_u32 s86, 2
    s_cbranch_scc1 Lrd_35
    s_cmp_eq_u32 s86, 1
    s_cbranch_scc1 Lr1_33
    s_branch Lrd_35
Lr1_33:
    s_cmp_eq_u32 s45, 0
    s_cbranch_scc1 Lrd_35
    s_add_u32 s53, s4, 0x00004000
    s_mov_b64 exec, 1
    buffer_atomic_add v132, off, s[28:31], s53 sc1
    s_mov_b64 exec, -1
    s_branch Lrd_35
Lrd_35:
    s_barrier
    s_cmp_ge_u32 s86, 2
    s_cbranch_scc1 Lr2_37
    s_cmp_eq_u32 s86, 1
    s_cbranch_scc1 Lrd_38
    s_add_u32 s53, s4, 0x00004000
    s_mov_b32 s52, 200000
    s_mov_b64 exec, 1
Lpc_40:
    v_mov_b32 v22, 0
    buffer_atomic_add v22, off, s[28:31], s53  sc0 sc1
    s_waitcnt vmcnt(0)
    v_cmp_gt_u32 vcc, 14, v22
    s_nop 1
    s_cbranch_vccz Lpd_41
    s_sub_u32 s52, s52, 1
    s_cmp_eq_u32 s52, 0
    s_cbranch_scc0 Lpc_40
    s_endpgm
Lpd_41:
    s_mov_b64 exec, -1
    v_mov_b32 v20, 163592
    s_mov_b64 exec, 1
    ds_write_b32 v20, v22
    s_mov_b64 exec, -1
    s_waitcnt lgkmcnt(0)
Lps_39:
    s_branch Lrd_38
Lr2_37:
    s_and_b32 s56, s86, 1
    s_mul_i32 s55, s56, 28672
    v_add_u32 v20, s55, v3
    v_add_u32 v21, s55, v4
    s_mul_i32 s55, s56, 14336
    v_add_u32 v23, s55, v8
    s_add_u32 s54, s42, 16
    s_mul_i32 s54, s54, 86016
    s_add_u32 s54, s54, 0x00400000
    s_add_u32 s53, s55, 57344
    s_add_u32 s56, s53, 14336
Lhq_42:
    s_mov_b32 m0, s53
    s_add_u32 s55, s53, s54
    buffer_load_dwordx4 v2, s[28:31], s55 offen sc1 lds
    s_add_u32 s53, s53, 1024
    s_cmp_lt_u32 s53, s56
    s_cbranch_scc1 Lhq_42
    ds_read_b64_tr_b16 v[28:29], v20 offset:0
    ds_read_b64_tr_b16 v[30:31], v20 offset:512
    ds_read_b64_tr_b16 v[32:33], v21 offset:0
    ds_read_b64_tr_b16 v[34:35], v21 offset:512
    ds_read_b64_tr_b16 v[36:37], v20 offset:2048
    ds_read_b64_tr_b16 v[38:39], v20 offset:2560
    ds_read_b64_tr_b16 v[40:41], v21 offset:2048
    ds_read_b64_tr_b16 v[42:43], v21 offset:2560
    ds_read_b64_tr_b16 v[44:45], v20 offset:4096
    ds_read_b64_tr_b16 v[46:47], v20 offset:4608
    ds_read_b64_tr_b16 v[48:49], v21 offset:4096
    ds_read_b64_tr_b16 v[50:51], v21 offset:4608
    s_waitcnt lgkmcnt(8)
    v_mfma_f32_32x32x16_bf16 v[80:95], v[24:27], v[28:31], 0
    v_mfma_f32_32x32x16_bf16 v[96:111], v[24:27], v[32:35], 0
    ds_read_b64_tr_b16 v[28:29], v20 offset:6144
    ds_read_b64_tr_b16 v[30:31], v20 offset:6656
    ds_read_b64_tr_b16 v[32:33], v21 offset:6144
    ds_read_b64_tr_b16 v[34:35], v21 offset:6656
    s_waitcnt lgkmcnt(8)
    v_mfma_f32_32x32x16_bf16 v[80:95], v[24:27], v[36:39], v[80:95]
    v_mfma_f32_32x32x16_bf16 v[96:111], v[24:27], v[40:43], v[96:111]
    ds_read_b64_tr_b16 v[36:37], v20 offset:8192
    ds_read_b64_tr_b16 v[38:39], v20 offset:8704
    ds_read_b64_tr_b16 v[40:41], v21 offset:8192
    ds_read_b64_tr_b16 v[42:43], v21 offset:8704
    s_waitcnt lgkmcnt(8)
    v_mfma_f32_32x32x16_bf16 v[80:95], v[24:27], v[44:47], v[80:95]
    v_mfma_f32_32x32x16_bf16 v[96:111], v[24:27], v[48:51], v[96:111]
    ds_read_b64_tr_b16 v[44:45], v20 offset:10240
    ds_read_b64_tr_b16 v[46:47], v20 offset:10752
    ds_read_b64_tr_b16 v[48:49], v21 offset:10240
    ds_read_b64_tr_b16 v[50:51], v21 offset:10752
    s_waitcnt lgkmcnt(8)
    v_mfma_f32_32x32x16_bf16 v[80:95], v[24:27], v[28:31], v[80:95]
    v_mfma_f32_32x32x16_bf16 v[96:111], v[24:27], v[32:35], v[96:111]
    ds_read_b64_tr_b16 v[28:29], v20 offset:12288
    ds_read_b64_tr_b16 v[30:31], v20 offset:12800
    ds_read_b64_tr_b16 v[32:33], v21 offset:12288
    ds_read_b64_tr_b16 v[34:35], v21 offset:12800
    s_waitcnt lgkmcnt(8)
    v_mfma_f32_32x32x16_bf16 v[80:95], v[24:27], v[36:39], v[80:95]
    v_mfma_f32_32x32x16_bf16 v[96:111], v[24:27], v[40:43], v[96:111]
    ds_read_b64_tr_b16 v[36:37], v20 offset:14336
    ds_read_b64_tr_b16 v[38:39], v20 offset:14848
    ds_read_b64_tr_b16 v[40:41], v21 offset:14336
    ds_read_b64_tr_b16 v[42:43], v21 offset:14848
    s_waitcnt lgkmcnt(8)
    v_mfma_f32_32x32x16_bf16 v[80:95], v[24:27], v[44:47], v[80:95]
    v_mfma_f32_32x32x16_bf16 v[96:111], v[24:27], v[48:51], v[96:111]
    ds_read_b64_tr_b16 v[44:45], v20 offset:16384
    ds_read_b64_tr_b16 v[46:47], v20 offset:16896
    ds_read_b64_tr_b16 v[48:49], v21 offset:16384
    ds_read_b64_tr_b16 v[50:51], v21 offset:16896
    s_waitcnt lgkmcnt(8)
    v_mfma_f32_32x32x16_bf16 v[80:95], v[24:27], v[28:31], v[80:95]
    v_mfma_f32_32x32x16_bf16 v[96:111], v[24:27], v[32:35], v[96:111]
    ds_read_b64_tr_b16 v[28:29], v20 offset:18432
    ds_read_b64_tr_b16 v[30:31], v20 offset:18944
    ds_read_b64_tr_b16 v[32:33], v21 offset:18432
    ds_read_b64_tr_b16 v[34:35], v21 offset:18944
    s_waitcnt lgkmcnt(8)
    v_mfma_f32_32x32x16_bf16 v[80:95], v[24:27], v[36:39], v[80:95]
    v_mfma_f32_32x32x16_bf16 v[96:111], v[24:27], v[40:43], v[96:111]
    ds_read_b64_tr_b16 v[36:37], v20 offset:20480
    ds_read_b64_tr_b16 v[38:39], v20 offset:20992
    ds_read_b64_tr_b16 v[40:41], v21 offset:20480
    ds_read_b64_tr_b16 v[42:43], v21 offset:20992
    s_waitcnt lgkmcnt(8)
    v_mfma_f32_32x32x16_bf16 v[80:95], v[24:27], v[44:47], v[80:95]
    v_mfma_f32_32x32x16_bf16 v[96:111], v[24:27], v[48:51], v[96:111]
    ds_read_b64_tr_b16 v[44:45], v20 offset:22528
    ds_read_b64_tr_b16 v[46:47], v20 offset:23040
    ds_read_b64_tr_b16 v[48:49], v21 offset:22528
    ds_read_b64_tr_b16 v[50:51], v21 offset:23040
    s_waitcnt lgkmcnt(8)
    v_mfma_f32_32x32x16_bf16 v[80:95], v[24:27], v[28:31], v[80:95]
    v_mfma_f32_32x32x16_bf16 v[96:111], v[24:27], v[32:35], v[96:111]
    ds_read_b64_tr_b16 v[28:29], v20 offset:24576
    ds_read_b64_tr_b16 v[30:31], v20 offset:25088
    ds_read_b64_tr_b16 v[32:33], v21 offset:24576
    ds_read_b64_tr_b16 v[34:35], v21 offset:25088
    s_waitcnt lgkmcnt(8)
    v_mfma_f32_32x32x16_bf16 v[80:95], v[24:27], v[36:39], v[80:95]
    v_mfma_f32_32x32x16_bf16 v[96:111], v[24:27], v[40:43], v[96:111]
    ds_read_b64_tr_b16 v[36:37], v20 offset:26624
    ds_read_b64_tr_b16 v[38:39], v20 offset:27136
    ds_read_b64_tr_b16 v[40:41], v21 offset:26624
    ds_read_b64_tr_b16 v[42:43], v21 offset:27136
    s_waitcnt lgkmcnt(8)
    v_mfma_f32_32x32x16_bf16 v[80:95], v[24:27], v[44:47], v[80:95]
    v_mfma_f32_32x32x16_bf16 v[96:111], v[24:27], v[48:51], v[96:111]
    s_waitcnt lgkmcnt(4)
    v_mfma_f32_32x32x16_bf16 v[80:95], v[24:27], v[28:31], v[80:95]
    v_mfma_f32_32x32x16_bf16 v[96:111], v[24:27], v[32:35], v[96:111]
    s_waitcnt lgkmcnt(0)
    v_mfma_f32_32x32x16_bf16 v[80:95], v[24:27], v[36:39], v[80:95]
    v_mfma_f32_32x32x16_bf16 v[96:111], v[24:27], v[40:43], v[96:111]
    s_and_b32 s55, s86, 1
    s_mul_i32 s55, s55, 384
    s_add_u32 s55, s55, 161792
    v_add_u32 v22, s55, v19
    s_nop 6
    ds_write_b32 v22, v80 offset:128
    ds_write_b32 v22, v96 offset:256
    s_waitcnt lgkmcnt(0)
Lrd_38:
    s_cmp_ge_u32 s86, 2
    s_cbranch_scc1 Lr2_44
    s_cmp_eq_u32 s86, 1
    s_cbranch_scc1 Lr1_43
    s_branch Lrd_45
Lr1_43:
    s_waitcnt vmcnt(0)
    s_branch Lrd_45
Lr2_44:
    s_waitcnt vmcnt(14)
Lrd_45:
    s_barrier
    s_cmp_ge_u32 s86, 2
    s_cbranch_scc1 Lr2_47
    s_cmp_eq_u32 s86, 1
    s_cbranch_scc1 Lrd_48
    s_branch Lrd_48
Lr2_47:
    s_waitcnt vmcnt(0)
    ds_read_b64_tr_b16 v[28:29], v23 offset:0
    ds_read_b64_tr_b16 v[30:31], v23 offset:256
    ds_read_b64_tr_b16 v[32:33], v23 offset:1024
    ds_read_b64_tr_b16 v[34:35], v23 offset:1280
    ds_read_b64_tr_b16 v[36:37], v23 offset:2048
    ds_read_b64_tr_b16 v[38:39], v23 offset:2304
    s_waitcnt lgkmcnt(4)
    v_mfma_f32_32x32x16_bf16 v[64:79], v[24:27], v[28:31], 0
    ds_read_b64_tr_b16 v[40:41], v23 offset:3072
    ds_read_b64_tr_b16 v[42:43], v23 offset:3328
    s_waitcnt lgkmcnt(4)
    v_mfma_f32_32x32x16_bf16 v[64:79], v[24:27], v[32:35], v[64:79]
    ds_read_b64_tr_b16 v[44:45], v23 offset:4096
    ds_read_b64_tr_b16 v[46:47], v23 offset:4352
    s_waitcnt lgkmcnt(4)
    v_mfma_f32_32x32x16_bf16 v[64:79], v[24:27], v[36:39], v[64:79]
    ds_read_b64_tr_b16 v[48:49], v23 offset:5120
    ds_read_b64_tr_b16 v[50:51], v23 offset:5376
    s_waitcnt lgkmcnt(4)
    v_mfma_f32_32x32x16_bf16 v[64:79], v[24:27], v[40:43], v[64:79]
    ds_read_b64_tr_b16 v[28:29], v23 offset:6144
    ds_read_b64_tr_b16 v[30:31], v23 offset:6400
    s_waitcnt lgkmcnt(4)
    v_mfma_f32_32x32x16_bf16 v[64:79], v[24:27], v[44:47], v[64:79]
    ds_read_b64_tr_b16 v[32:33], v23 offset:7168
    ds_read_b64_tr_b16 v[34:35], v23 offset:7424
    s_waitcnt lgkmcnt(4)
    v_mfma_f32_32x32x16_bf16 v[64:79], v[24:27], v[48:51], v[64:79]
    ds_read_b64_tr_b16 v[36:37], v23 offset:8192
    ds_read_b64_tr_b16 v[38:39], v23 offset:8448
    s_waitcnt lgkmcnt(4)
    v_mfma_f32_32x32x16_bf16 v[64:79], v[24:27], v[28:31], v[64:79]
    ds_read_b64_tr_b16 v[40:41], v23 offset:9216
    ds_read_b64_tr_b16 v[42:43], v23 offset:9472
    s_waitcnt lgkmcnt(4)
    v_mfma_f32_32x32x16_bf16 v[64:79], v[24:27], v[32:35], v[64:79]
    ds_read_b64_tr_b16 v[44:45], v23 offset:10240
    ds_read_b64_tr_b16 v[46:47], v23 offset:10496
    s_waitcnt lgkmcnt(4)
    v_mfma_f32_32x32x16_bf16 v[64:79], v[24:27], v[36:39], v[64:79]
    ds_read_b64_tr_b16 v[48:49], v23 offset:11264
    ds_read_b64_tr_b16 v[50:51], v23 offset:11520
    s_waitcnt lgkmcnt(4)
    v_mfma_f32_32x32x16_bf16 v[64:79], v[24:27], v[40:43], v[64:79]
    ds_read_b64_tr_b16 v[28:29], v23 offset:12288
    ds_read_b64_tr_b16 v[30:31], v23 offset:12544
    s_waitcnt lgkmcnt(4)
    v_mfma_f32_32x32x16_bf16 v[64:79], v[24:27], v[44:47], v[64:79]
    ds_read_b64_tr_b16 v[32:33], v23 offset:13312
    ds_read_b64_tr_b16 v[34:35], v23 offset:13568
    s_waitcnt lgkmcnt(4)
    v_mfma_f32_32x32x16_bf16 v[64:79], v[24:27], v[48:51], v[64:79]
    s_waitcnt lgkmcnt(2)
    v_mfma_f32_32x32x16_bf16 v[64:79], v[24:27], v[28:31], v[64:79]
    s_waitcnt lgkmcnt(0)
    v_mfma_f32_32x32x16_bf16 v[64:79], v[24:27], v[32:35], v[64:79]
    s_and_b32 s55, s86, 1
    s_mul_i32 s55, s55, 384
    s_add_u32 s55, s55, 161792
    v_add_u32 v22, s55, v19
    s_nop 7
    ds_write_b32 v22, v64 offset:0
    s_waitcnt lgkmcnt(0)
Lrd_48:
    s_waitcnt vmcnt(0)
    s_barrier
    s_cmp_ge_u32 s86, 2
    s_cbranch_scc1 Lrd_52
    s_cmp_eq_u32 s86, 1
    s_cbranch_scc1 Lrd_52
    s_add_u32 s53, s3, 0x00006000
    v_lshrrev_b32 v21, 4, v1
    v_lshlrev_b32 v21, 7, v21
    v_and_b32 v20, 15, v1
    v_lshl_add_u32 v21, v20, 2, v21
    s_mov_b32 s52, 200000
Lpw_54:
    v_mov_b32 v23, 0
    buffer_atomic_add v23, v21, s[28:31], s53 offen sc0 sc1
    s_waitcnt vmcnt(0)
    v_cmp_eq_u32 vcc, 0, v23
    s_nop 1
    s_cbranch_vccz Lpd_55
    s_sub_u32 s52, s52, 1
    s_cmp_eq_u32 s52, 0
    s_cbranch_scc0 Lpw_54
    s_endpgm
Lpd_55:
    v_max_u32_dpp v23, v23, v23 row_ror:1 row_mask:0xf bank_mask:0xf
    s_nop 1
    v_max_u32_dpp v23, v23, v23 row_ror:2 row_mask:0xf bank_mask:0xf
    s_nop 1
    v_max_u32_dpp v23, v23, v23 row_ror:4 row_mask:0xf bank_mask:0xf
    s_nop 1
    v_max_u32_dpp v23, v23, v23 row_ror:8 row_mask:0xf bank_mask:0xf
    s_nop 0
    v_readlane_b32 s53, v23, 16
    v_readlane_b32 s54, v23, 32
    v_readlane_b32 s55, v23, 48
    s_nop 0
    s_max_u32 s53, s53, s54
    s_nop 0
    s_max_u32 s53, s53, s55
    v_max_u32 v23, s53, v23
    v_mov_b32 v20, 163596
    s_mov_b64 exec, 1
    ds_write_b32 v20, v23
    s_mov_b64 exec, -1
    s_waitcnt lgkmcnt(0)
Lps_53:
    s_branch Lrd_52
Lrd_52:
    s_barrier
    s_mov_b32 s16, s74
    s_mov_b32 s17, s75
    s_and_b32 s55, s86, 3
    s_lshl_b32 s53, s55, 10
    s_add_u32 s53, s53, 86016
    s_mul_i32 s54, s55, 7168
    s_lshl_b32 s55, s44, 7
    s_add_u32 s54, s54, s55
Lho_56:
    s_mov_b32 m0, s53
    s_add_u32 s53, s53, 4096
    buffer_load_dwordx4 v18, s[16:19], s54 offen lds
    s_waitcnt vmcnt(2)
    s_add_u32 s54, s54, 28672
    s_cmp_lt_u32 s53, 144384
    s_cbranch_scc1 Lho_56
    s_add_u32 s54, s42, 0
    s_mul_i32 s54, s54, 86016
    s_add_u32 s54, s54, 0x00400000
    s_and_b32 s53, s86, 3
    s_lshl_b32 s53, s53, 10
    s_add_u32 s53, s53, 0
Lhq_57:
    s_mov_b32 m0, s53
    s_add_u32 s55, s53, s54
    buffer_load_dwordx4 v2, s[28:31], s55 offen sc1 lds
    s_waitcnt vmcnt(2)
    s_add_u32 s53, s53, 4096
    s_cmp_lt_u32 s53, 36864
    s_cbranch_scc1 Lhq_57
    s_cmp_eq_u32 s45, 0
    s_cbranch_scc1 Lpf_58
    s_mul_i32 s55, s49, 14
    s_add_u32 s55, s55, s50
    s_lshl_b32 s82, s55, 11
    s_add_u32 s82, s82, 0x02000000
    s_lshl_b32 s55, s55, 8
    s_add_u32 s55, s55, 0x02800000
    buffer_store_dwordx4 v[128:131], v2, s[28:31], s82 offen offset:0 sc1
    s_waitcnt vmcnt(2)
    buffer_store_dwordx4 v[128:131], v2, s[28:31], s82 offen offset:1024 sc1
    s_waitcnt vmcnt(2)
    s_mov_b64 exec, 0xffff
    buffer_store_dwordx4 v[128:131], v2, s[28:31], s55 offen offset:0 sc1
    s_waitcnt vmcnt(2)
    s_mov_b64 exec, -1
Lpf_58:
    s_lshl_b32 s55, s48, 4
    s_add_u32 s55, s55, s42
    s_lshl_b32 s55, s55, 11
    s_add_u32 s55, s55, 0x03200000
    buffer_store_dwordx4 v[128:131], v2, s[28:31], s55 offen offset:0 sc1
    s_waitcnt vmcnt(2)
    buffer_store_dwordx4 v[128:131], v2, s[28:31], s55 offen offset:1024 sc1
    s_waitcnt vmcnt(2)
    s_lshl_b32 s55, s7, 11
    s_and_b32 s82, s40, 1
    s_lshl_b32 s82, s82, 10
    s_add_u32 s55, s55, s82
    s_add_u32 s55, s55, 0x03400000
    buffer_store_dwordx4 v[128:131], v2, s[28:31], s55 offen offset:0 sc1
    s_waitcnt vmcnt(2)
    s_cmp_eq_u32 s45, 0
    s_cbranch_scc1 Lpf_59
    s_mul_i32 s55, s49, 14
    s_add_u32 s55, s55, s50
    s_lshl_b32 s82, s55, 11
    s_add_u32 s82, s82, 0x03000000
    s_lshl_b32 s55, s55, 8
    s_add_u32 s55, s55, 0x03800000
    buffer_store_dwordx4 v[128:131], v2, s[28:31], s82 offen offset:0 sc1
    s_waitcnt vmcnt(2)
    buffer_store_dwordx4 v[128:131], v2, s[28:31], s82 offen offset:1024 sc1
    s_waitcnt vmcnt(2)
    s_mov_b64 exec, 0xffff
    buffer_store_dwordx4 v[128:131], v2, s[28:31], s55 offen offset:0 sc1
    s_waitcnt vmcnt(2)
    s_mov_b64 exec, -1
Lpf_59:
    s_lshl_b32 s55, s48, 4
    s_add_u32 s55, s55, s42
    s_lshl_b32 s55, s55, 11
    s_add_u32 s55, s55, 0x04200000
    buffer_store_dwordx4 v[128:131], v2, s[28:31], s55 offen offset:0 sc1
    s_waitcnt vmcnt(2)
    buffer_store_dwordx4 v[128:131], v2, s[28:31], s55 offen offset:1024 sc1
    s_waitcnt vmcnt(2)
    s_lshl_b32 s55, s42, 6
    s_add_u32 s55, s55, s48
    s_lshl_b32 s55, s55, 12
    s_add_u32 s55, s55, 0x04400000
    buffer_store_dwordx4 v[128:131], v2, s[28:31], s55 offen offset:0 sc1
    s_waitcnt vmcnt(2)
    buffer_store_dwordx4 v[128:131], v2, s[28:31], s55 offen offset:1024 sc1
    s_waitcnt vmcnt(2)
    buffer_store_dwordx4 v[128:131], v2, s[28:31], s55 offen offset:2048 sc1
    s_waitcnt vmcnt(2)
    buffer_store_dwordx4 v[128:131], v2, s[28:31], s55 offen offset:3072 sc1
    s_waitcnt vmcnt(2)
    s_waitcnt vmcnt(0)
    s_barrier
    s_cmp_ge_u32 s86, 2
    s_cbranch_scc1 Lrd_62
    s_cmp_eq_u32 s86, 1
    s_cbranch_scc1 Lr1_60
    s_branch Lrd_62
Lr1_60:
    s_add_u32 s53, s4, 0x00008000
    s_mov_b64 exec, 1
    buffer_atomic_add v132, off, s[28:31], s53 sc1
    s_mov_b64 exec, -1
    s_branch Lrd_62
Lrd_62:
    s_barrier
    s_cmp_ge_u32 s86, 2
    s_cbranch_scc1 Lr2_64
    s_cmp_eq_u32 s86, 1
    s_cbranch_scc1 Lrd_65
    s_cmp_eq_u32 s45, 0
    s_cbranch_scc1 Lps_66
    s_add_u32 s53, s5, 0x00008000
    s_mov_b32 s52, 200000
    s_mov_b64 exec, 1
Lpc_67:
    v_mov_b32 v22, 0
    buffer_atomic_add v22, off, s[28:31], s53  sc0 sc1
    s_waitcnt vmcnt(0)
    v_cmp_gt_u32 vcc, 16, v22
    s_nop 1
    s_cbranch_vccz Lpd_68
    s_sub_u32 s52, s52, 1
    s_cmp_eq_u32 s52, 0
    s_cbranch_scc0 Lpc_67
    s_endpgm
Lpd_68:
    s_mov_b64 exec, -1
    v_mov_b32 v20, 163600
    s_mov_b64 exec, 1
    ds_write_b32 v20, v22
    s_mov_b64 exec, -1
    s_waitcnt lgkmcnt(0)
Lps_66:
    s_branch Lrd_65
Lr2_64:
    s_add_u32 s54, s42, 0
    s_mul_i32 s54, s54, 86016
    s_add_u32 s54, s54, 0x00400000
    s_and_b32 s53, s86, 1
    s_lshl_b32 s53, s53, 10
    s_add_u32 s53, s53, 36864
Lhq_69:
    s_mov_b32 m0, s53
    s_add_u32 s55, s53, s54
    buffer_load_dwordx4 v2, s[28:31], s55 offen sc1 lds
    s_add_u32 s53, s53, 2048
    s_cmp_lt_u32 s53, 86016
    s_cbranch_scc1 Lhq_69
Lrd_65:
    s_barrier
    s_waitcnt vmcnt(0)
    s_barrier
    s_cmp_ge_u32 s86, 2
    s_cbranch_scc1 Lrd_72
    s_cmp_eq_u32 s86, 1
    s_cbranch_scc1 Lr1_70
    s_branch Lrd_72
Lr1_70:
    s_cmp_eq_u32 s45, 0
    s_cbranch_scc1 Lrd_72
    s_add_u32 s53, s4, 0x0000a000
    s_mov_b64 exec, 1
    buffer_atomic_add v132, off, s[28:31], s53 sc1
    s_mov_b64 exec, -1
    s_branch Lrd_72
Lrd_72:
    s_barrier
    s_cmp_ge_u32 s86, 2
    s_cbranch_scc1 Lr2_74
    s_cmp_eq_u32 s86, 1
    s_cbranch_scc1 Lrd_75
    s_add_u32 s53, s4, 0x0000a000
    s_mov_b32 s52, 200000
    s_mov_b64 exec, 1
Lpc_77:
    v_mov_b32 v22, 0
    buffer_atomic_add v22, off, s[28:31], s53  sc0 sc1
    s_waitcnt vmcnt(0)
    v_cmp_gt_u32 vcc, 14, v22
    s_nop 1
    s_cbranch_vccz Lpd_78
    s_sub_u32 s52, s52, 1
    s_cmp_eq_u32 s52, 0
    s_cbranch_scc0 Lpc_77
    s_endpgm
Lpd_78:
    s_mov_b64 exec, -1
    v_mov_b32 v20, 163604
    s_mov_b64 exec, 1
    ds_write_b32 v20, v22
    s_mov_b64 exec, -1
    s_waitcnt lgkmcnt(0)
Lps_76:
    s_branch Lrd_75
Lr2_74:
    s_mov_b32 s16, s68
    s_mov_b32 s17, s69
    s_and_b32 s55, s86, 1
    s_lshl_b32 s53, s55, 10
    s_add_u32 s53, s53, 86016
    s_mul_i32 s54, s55, 7168
    s_lshl_b32 s55, s44, 7
    s_add_u32 s54, s54, s55
Lho_79:
    s_mov_b32 m0, s53
    s_add_u32 s53, s53, 2048
    buffer_load_dwordx4 v18, s[16:19], s54 offen lds
    s_add_u32 s54, s54, 14336
    s_cmp_lt_u32 s53, 144384
    s_cbranch_scc1 Lho_79
Lrd_75:
    s_barrier
    s_barrier
    s_cmp_ge_u32 s86, 2
    s_cbranch_scc1 Lr2_81
    s_cmp_eq_u32 s86, 1
    s_cbranch_scc1 Lr1_80
    s_add_u32 s53, s3, 0x0000c000
    s_mov_b32 s52, 200000
    s_mov_b64 exec, 1
Lpc_84:
    v_mov_b32 v22, 0
    buffer_atomic_add v22, off, s[28:31], s53  sc0 sc1
    s_waitcnt vmcnt(0)
    v_cmp_gt_u32 vcc, 16, v22
    s_nop 1
    s_cbranch_vccz Lpd_85
    s_sub_u32 s52, s52, 1
    s_cmp_eq_u32 s52, 0
    s_cbranch_scc0 Lpc_84
    s_endpgm
Lpd_85:
    s_mov_b64 exec, -1
Lps_83:
    s_branch Lrd_82
Lr1_80:
    s_add_u32 s53, s3, 0x0000c000
    s_mov_b64 exec, 1
    buffer_atomic_add v132, off, s[28:31], s53 sc1
    s_mov_b64 exec, -1
    s_branch Lrd_82
Lr2_81:
    s_add_u32 s54, s42, 16
    s_mul_i32 s54, s54, 86016
    s_add_u32 s54, s54, 0x00400000
    s_and_b32 s53, s86, 1
    s_lshl_b32 s53, s53, 10
    s_add_u32 s53, s53, 0
Lhq_86:
    s_mov_b32 m0, s53
    s_add_u32 s55, s53, s54
    buffer_load_dwordx4 v2, s[28:31], s55 offen sc1 lds
    s_add_u32 s53, s53, 2048
    s_cmp_lt_u32 s53, 49152
    s_cbranch_scc1 Lhq_86
Lrd_82:
    s_barrier
    s_waitcnt vmcnt(0)
    s_barrier
    s_barrier
    s_cmp_ge_u32 s86, 2
    s_cbranch_scc1 Lr2_88
    s_cmp_eq_u32 s86, 1
    s_cbranch_scc1 Lr1_87
    s_cmp_eq_u32 s45, 0
    s_cbranch_scc1 Lps_90
    s_add_u32 s53, s5, 0x0000e000
    s_mov_b32 s52, 200000
    s_mov_b64 exec, 1
Lpc_91:
    v_mov_b32 v22, 0
    buffer_atomic_add v22, off, s[28:31], s53  sc0 sc1
    s_waitcnt vmcnt(0)
    v_cmp_gt_u32 vcc, 16, v22
    s_nop 1
    s_cbranch_vccz Lpd_92
    s_sub_u32 s52, s52, 1
    s_cmp_eq_u32 s52, 0
    s_cbranch_scc0 Lpc_91
    s_endpgm
Lpd_92:
    s_mov_b64 exec, -1
    v_mov_b32 v20, 163612
    s_mov_b64 exec, 1
    ds_write_b32 v20, v22
    s_mov_b64 exec, -1
    s_waitcnt lgkmcnt(0)
Lps_90:
    s_branch Lrd_89
Lr1_87:
    s_add_u32 s53, s4, 0x0000e000
    s_mov_b64 exec, 1
    buffer_atomic_add v132, off, s[28:31], s53 sc1
    s_mov_b64 exec, -1
    s_branch Lrd_89
Lr2_88:
    s_add_u32 s54, s42, 16
    s_mul_i32 s54, s54, 86016
    s_add_u32 s54, s54, 0x00400000
    s_and_b32 s53, s86, 1
    s_lshl_b32 s53, s53, 10
    s_add_u32 s53, s53, 49152
Lhq_93:
    s_mov_b32 m0, s53
    s_add_u32 s55, s53, s54
    buffer_load_dwordx4 v2, s[28:31], s55 offen sc1 lds
    s_add_u32 s53, s53, 2048
    s_cmp_lt_u32 s53, 86016
    s_cbranch_scc1 Lhq_93
Lrd_89:
    s_barrier
    s_waitcnt vmcnt(0)
    s_barrier
    s_cmp_ge_u32 s86, 2
    s_cbranch_scc1 Lrd_96
    s_cmp_eq_u32 s86, 1
    s_cbranch_scc1 Lr1_94
    s_branch Lrd_96
Lr1_94:
    s_cmp_eq_u32 s45, 0
    s_cbranch_scc1 Lrd_96
    s_add_u32 s53, s4, 0x00010000
    s_mov_b64 exec, 1
    buffer_atomic_add v132, off, s[28:31], s53 sc1
    s_mov_b64 exec, -1
    s_branch Lrd_96
Lrd_96:
    s_barrier
    s_cmp_ge_u32 s86, 2
    s_cbranch_scc1 Lrd_99
    s_cmp_eq_u32 s86, 1
    s_cbranch_scc1 Lrd_99
    s_add_u32 s53, s4, 0x00010000
    s_mov_b32 s52, 200000
    s_mov_b64 exec, 1
Lpc_101:
    v_mov_b32 v22, 0
    buffer_atomic_add v22, off, s[28:31], s53  sc0 sc1
    s_waitcnt vmcnt(0)
    v_cmp_gt_u32 vcc, 14, v22
    s_nop 1
    s_cbranch_vccz Lpd_102
    s_sub_u32 s52, s52, 1
    s_cmp_eq_u32 s52, 0
    s_cbranch_scc0 Lpc_101
    s_endpgm
Lpd_102:
    s_mov_b64 exec, -1
    v_mov_b32 v20, 163616
    s_mov_b64 exec, 1
    ds_write_b32 v20, v22
    s_mov_b64 exec, -1
    s_waitcnt lgkmcnt(0)
Lps_100:
    s_branch Lrd_99
Lrd_99:
    s_barrier
    s_cmp_ge_u32 s86, 2
    s_cbranch_scc1 Lrd_105
    s_cmp_eq_u32 s86, 1
    s_cbranch_scc1 Lrd_105
    s_add_u32 s53, s3, 0x00012000
    v_lshrrev_b32 v21, 4, v1
    v_lshlrev_b32 v21, 7, v21
    v_and_b32 v20, 15, v1
    v_lshl_add_u32 v21, v20, 2, v21
    s_mov_b32 s52, 200000
Lpw_107:
    v_mov_b32 v23, 0
    buffer_atomic_add v23, v21, s[28:31], s53 offen sc0 sc1
    s_waitcnt vmcnt(0)
    v_cmp_eq_u32 vcc, 0, v23
    s_nop 1
    s_cbranch_vccz Lpd_108
    s_sub_u32 s52, s52, 1
    s_cmp_eq_u32 s52, 0
    s_cbranch_scc0 Lpw_107
    s_endpgm
Lpd_108:
    v_max_u32_dpp v23, v23, v23 row_ror:1 row_mask:0xf bank_mask:0xf
    s_nop 1
    v_max_u32_dpp v23, v23, v23 row_ror:2 row_mask:0xf bank_mask:0xf
    s_nop 1
    v_max_u32_dpp v23, v23, v23 row_ror:4 row_mask:0xf bank_mask:0xf
    s_nop 1
    v_max_u32_dpp v23, v23, v23 row_ror:8 row_mask:0xf bank_mask:0xf
    s_nop 0
    v_readlane_b32 s53, v23, 16
    v_readlane_b32 s54, v23, 32
    v_readlane_b32 s55, v23, 48
    s_nop 0
    s_max_u32 s53, s53, s54
    s_nop 0
    s_max_u32 s53, s53, s55
    v_max_u32 v23, s53, v23
    v_mov_b32 v20, 163620
    s_mov_b64 exec, 1
    ds_write_b32 v20, v23
    s_mov_b64 exec, -1
    s_waitcnt lgkmcnt(0)
Lps_106:
    s_branch Lrd_105
Lrd_105:
    s_barrier
    s_mov_b32 s16, s74
    s_mov_b32 s17, s75
    s_and_b32 s55, s86, 3
    s_lshl_b32 s53, s55, 10
    s_add_u32 s53, s53, 86016
    s_mul_i32 s54, s55, 7168
    s_lshl_b32 s55, s44, 7
    s_add_u32 s54, s54, s55
Lho_109:
    s_mov_b32 m0, s53
    s_add_u32 s53, s53, 4096
    buffer_load_dwordx4 v18, s[16:19], s54 offen lds
    s_waitcnt vmcnt(2)
    s_add_u32 s54, s54, 28672
    s_cmp_lt_u32 s53, 144384
    s_cbranch_scc1 Lho_109
    s_waitcnt vmcnt(0)
    s_barrier
    s_cmp_ge_u32 s86, 2
    s_cbranch_scc1 Lrd_112
    s_cmp_eq_u32 s86, 1
    s_cbranch_scc1 Lr1_110
    s_branch Lrd_112
Lr1_110:
    s_add_u32 s53, s4, 0x00014000
    s_mov_b64 exec, 1
    buffer_atomic_add v132, off, s[28:31], s53 sc1
    s_mov_b64 exec, -1
    s_branch Lrd_112
Lrd_112:
    s_barrier
    s_cmp_ge_u32 s86, 2
    s_cbranch_scc1 Lrd_115
    s_cmp_eq_u32 s86, 1
    s_cbranch_scc1 Lrd_115
    s_cmp_eq_u32 s45, 0
    s_cbranch_scc1 Lps_116
    s_add_u32 s53, s5, 0x00014000
    s_mov_b32 s52, 200000
    s_mov_b64 exec, 1
Lpc_117:
    v_mov_b32 v22, 0
    buffer_atomic_add v22, off, s[28:31], s53  sc0 sc1
    s_waitcnt vmcnt(0)
    v_cmp_gt_u32 vcc, 16, v22
    s_nop 1
    s_cbranch_vccz Lpd_118
    s_sub_u32 s52, s52, 1
    s_cmp_eq_u32 s52, 0
    s_cbranch_scc0 Lpc_117
    s_endpgm
Lpd_118:
    s_mov_b64 exec, -1
    v_mov_b32 v20, 163624
    s_mov_b64 exec, 1
    ds_write_b32 v20, v22
    s_mov_b64 exec, -1
    s_waitcnt lgkmcnt(0)
Lps_116:
    s_branch Lrd_115
Lrd_115:
    s_barrier
    s_branch L_fin
L_layerA:
    s_mov_b32 s62, 0x3fb8aa3b
    s_mov_b32 s63, 0x358637bd
    s_mov_b32 s96, 3
    s_mov_b32 s6, 0
    s_mul_i32 s94, s48, 28672
    v_lshrrev_b32 v22, 3, v1
    v_and_b32 v23, 7, v1
    v_lshrrev_b32 v24, 4, v1
    v_xor_b32 v23, v23, v24
    v_mul_u32_u24 v22, 896, v22
    v_lshl_add_u32 v224, v23, 4, v22
    v_xor_b32 v23, 4, v23
    v_lshl_add_u32 v225, v23, 4, v22
    s_lshl_b32 s58, s40, 14
    s_add_u32 s58, s58, 86016
    s_lshl_b32 s98, s84, 7
    s_add_u32 s98, s98, s94
    s_add_u32 s99, s94, 896
    s_add_u32 m0, s58, 0
    s_add_u32 s53, s98, 0
    buffer_load_dwordx4 v224, s[8:11], s53 offen lds
    s_add_u32 m0, s58, 1024
    s_add_u32 s53, s98, 7168
    buffer_load_dwordx4 v225, s[8:11], s53 offen lds
    s_add_u32 m0, s58, 2048
    s_add_u32 s53, s98, 14336
    buffer_load_dwordx4 v224, s[8:11], s53 offen lds
    s_add_u32 m0, s58, 3072
    s_add_u32 s53, s98, 21504
    buffer_load_dwordx4 v225, s[8:11], s53 offen lds
    s_add_u32 s98, s98, 128
    s_cmp_eq_u32 s98, s99
    s_cselect_b32 s98, s94, s98
    s_add_u32 m0, s58, 4096
    s_add_u32 s53, s98, 0
    buffer_load_dwordx4 v224, s[8:11], s53 offen lds
    s_add_u32 m0, s58, 5120
    s_add_u32 s53, s98, 7168
    buffer_load_dwordx4 v225, s[8:11], s53 offen lds
    s_add_u32 m0, s58, 6144
    s_add_u32 s53, s98, 14336
    buffer_load_dwordx4 v224, s[8:11], s53 offen lds
    s_add_u32 m0, s58, 7168
    s_add_u32 s53, s98, 21504
    buffer_load_dwordx4 v225, s[8:11], s53 offen lds
    s_add_u32 s98, s98, 128
    s_cmp_eq_u32 s98, s99
    s_cselect_b32 s98, s94, s98
    s_add_u32 m0, s58, 8192
    s_add_u32 s53, s98, 0
    buffer_load_dwordx4 v224, s[8:11], s53 offen lds
    s_add_u32 m0, s58, 9216
    s_add_u32 s53, s98, 7168
    buffer_load_dwordx4 v225, s[8:11], s53 offen lds
    s_add_u32 m0, s58, 10240
    s_add_u32 s53, s98, 14336
    buffer_load_dwordx4 v224, s[8:11], s53 offen lds
    s_add_u32 m0, s58, 11264
    s_add_u32 s53, s98, 21504
    buffer_load_dwordx4 v225, s[8:11], s53 offen lds
    s_add_u32 s98, s98, 128
    s_cmp_eq_u32 s98, s99
    s_cselect_b32 s98, s94, s98
    s_add_u32 m0, s58, 12288
    s_add_u32 s53, s98, 0
    buffer_load_dwordx4 v224, s[8:11], s53 offen lds
    s_add_u32 m0, s58, 13312
    s_add_u32 s53, s98, 7168
    buffer_load_dwordx4 v225, s[8:11], s53 offen lds
    s_add_u32 m0, s58, 14336
    s_add_u32 s53, s98, 14336
    buffer_load_dwordx4 v224, s[8:11], s53 offen lds
    s_add_u32 m0, s58, 15360
    s_add_u32 s53, s98, 21504
    buffer_load_dwordx4 v225, s[8:11], s53 offen lds
    s_add_u32 s98, s98, 128
    s_cmp_eq_u32 s98, s99
    s_cselect_b32 s98, s94, s98
    s_mov_b32 s54, 0x3f803f80
    v_and_b32 v22, 31, v1
    v_lshrrev_b32 v23, 5, v1
    v_bfe_u32 v24, v1, 1, 3
    v_xor_b32 v23, v23, v24
    v_lshlrev_b32 v23, 4, v23
    v_lshl_add_u32 v22, v22, 7, v23
    v_xor_b32 v226, 0, v22
    v_add_u32 v226, s58, v226
    v_xor_b32 v227, 32, v22
    v_add_u32 v227, s58, v227
    v_xor_b32 v228, 64, v22
    v_add_u32 v228, s58, v228
    v_xor_b32 v229, 96, v22
    v_add_u32 v229, s58, v229
    v_mov_b32 v176, 0
    v_mov_b32 v180, -1
    v_mov_b32 v177, 0
    v_mov_b32 v181, -1
    v_mov_b32 v178, 0
    v_mov_b32 v182, -1
    v_mov_b32 v179, 0
    v_mov_b32 v183, -1
    s_waitcnt vmcnt(12)
    ds_read_b128 v[32:35], v226 offset:0
    ds_read_b128 v[36:39], v227 offset:0
    ds_read_b128 v[40:43], v228 offset:0
    ds_read_b128 v[44:47], v229 offset:0
    s_waitcnt lgkmcnt(3)
    v_dot2_f32_bf16 v176, v32, s54, v176
    v_dot2_f32_bf16 v177, v32, v32, v177
    v_dot2_f32_bf16 v178, v33, s54, v178
    v_dot2_f32_bf16 v179, v33, v33, v179
    v_dot2_f32_bf16 v176, v34, s54, v176
    v_dot2_f32_bf16 v177, v34, v34, v177
    v_dot2_f32_bf16 v178, v35, s54, v178
    v_dot2_f32_bf16 v179, v35, v35, v179
    s_waitcnt lgkmcnt(2)
    v_dot2_f32_bf16 v176, v36, s54, v176
    v_dot2_f32_bf16 v177, v36, v36, v177
    v_dot2_f32_bf16 v178, v37, s54, v178
    v_dot2_f32_bf16 v179, v37, v37, v179
    v_dot2_f32_bf16 v176, v38, s54, v176
    v_dot2_f32_bf16 v177, v38, v38, v177
    v_dot2_f32_bf16 v178, v39, s54, v178
    v_dot2_f32_bf16 v179, v39, v39, v179
    s_waitcnt lgkmcnt(1)
    v_dot2_f32_bf16 v176, v40, s54, v176
    v_dot2_f32_bf16 v177, v40, v40, v177
    v_dot2_f32_bf16 v178, v41, s54, v178
    v_dot2_f32_bf16 v179, v41, v41, v179
    v_dot2_f32_bf16 v176, v42, s54, v176
    v_dot2_f32_bf16 v177, v42, v42, v177
    v_dot2_f32_bf16 v178, v43, s54, v178
    v_dot2_f32_bf16 v179, v43, v43, v179
    s_waitcnt lgkmcnt(0)
    s_add_u32 m0, s58, 0
    s_add_u32 s53, s98, 0
    buffer_load_dwordx4 v224, s[8:11], s53 offen lds
    s_add_u32 m0, s58, 1024
    s_add_u32 s53, s98, 7168
    buffer_load_dwordx4 v225, s[8:11], s53 offen lds
    s_add_u32 m0, s58, 2048
    s_add_u32 s53, s98, 14336
    buffer_load_dwordx4 v224, s[8:11], s53 offen lds
    s_add_u32 m0, s58, 3072
    s_add_u32 s53, s98, 21504
    buffer_load_dwordx4 v225, s[8:11], s53 offen lds
    s_add_u32 s98, s98, 128
    s_cmp_eq_u32 s98, s99
    s_cselect_b32 s98, s94, s98
    v_dot2_f32_bf16 v176, v44, s54, v176
    v_dot2_f32_bf16 v177, v44, v44, v177
    v_dot2_f32_bf16 v178, v45, s54, v178
    v_dot2_f32_bf16 v179, v45, v45, v179
    v_dot2_f32_bf16 v176, v46, s54, v176
    v_dot2_f32_bf16 v177, v46, v46, v177
    v_dot2_f32_bf16 v178, v47, s54, v178
    v_dot2_f32_bf16 v179, v47, v47, v179
    s_waitcnt vmcnt(12)
    ds_read_b128 v[48:51], v226 offset:4096
    ds_read_b128 v[52:55], v227 offset:4096
    ds_read_b128 v[56:59], v228 offset:4096
    ds_read_b128 v[60:63], v229 offset:4096
    s_waitcnt lgkmcnt(3)
    v_dot2_f32_bf16 v176, v48, s54, v176
    v_dot2_f32_bf16 v177, v48, v48, v177
    v_dot2_f32_bf16 v178, v49, s54, v178
    v_dot2_f32_bf16 v179, v49, v49, v179
    v_dot2_f32_bf16 v176, v50, s54, v176
    v_dot2_f32_bf16 v177, v50, v50, v177
    v_dot2_f32_bf16 v178, v51, s54, v178
    v_dot2_f32_bf16 v179, v51, v51, v179
    s_waitcnt lgkmcnt(2)
    v_dot2_f32_bf16 v176, v52, s54, v176
    v_dot2_f32_bf16 v177, v52, v52, v177
    v_dot2_f32_bf16 v178, v53, s54, v178
    v_dot2_f32_bf16 v179, v53, v53, v179
    v_dot2_f32_bf16 v176, v54, s54, v176
    v_dot2_f32_bf16 v177, v54, v54, v177
    v_dot2_f32_bf16 v178, v55, s54, v178
    v_dot2_f32_bf16 v179, v55, v55, v179
    s_waitcnt lgkmcnt(1)
    v_dot2_f32_bf16 v176, v56, s54, v176
    v_dot2_f32_bf16 v177, v56, v56, v177
    v_dot2_f32_bf16 v178, v57, s54, v178
    v_dot2_f32_bf16 v179, v57, v57, v179
    v_dot2_f32_bf16 v176, v58, s54, v176
    v_dot2_f32_bf16 v177, v58, v58, v177
    v_dot2_f32_bf16 v178, v59, s54, v178
    v_dot2_f32_bf16 v179, v59, v59, v179
    s_waitcnt lgkmcnt(0)
    s_add_u32 m0, s58, 4096
    s_add_u32 s53, s98, 0
    buffer_load_dwordx4 v224, s[8:11], s53 offen lds
    s_add_u32 m0, s58, 5120
    s_add_u32 s53, s98, 7168
    buffer_load_dwordx4 v225, s[8:11], s53 offen lds
    s_add_u32 m0, s58, 6144
    s_add_u32 s53, s98, 14336
    buffer_load_dwordx4 v224, s[8:11], s53 offen lds
    s_add_u32 m0, s58, 7168
    s_add_u32 s53, s98, 21504
    buffer_load_dwordx4 v225, s[8:11], s53 offen lds
    s_add_u32 s98, s98, 128
    s_cmp_eq_u32 s98, s99
    s_cselect_b32 s98, s94, s98
    v_dot2_f32_bf16 v176, v60, s54, v176
    v_dot2_f32_bf16 v177, v60, v60, v177
    v_dot2_f32_bf16 v178, v61, s54, v178
    v_dot2_f32_bf16 v179, v61, v61, v179
    v_dot2_f32_bf16 v176, v62, s54, v176
    v_dot2_f32_bf16 v177, v62, v62, v177
    v_dot2_f32_bf16 v178, v63, s54, v178
    v_dot2_f32_bf16 v179, v63, v63, v179
    s_waitcnt vmcnt(12)
    ds_read_b128 v[64:67], v226 offset:8192
    ds_read_b128 v[68:71], v227 offset:8192
    ds_read_b128 v[72:75], v228 offset:8192
    ds_read_b128 v[76:79], v229 offset:8192
    s_waitcnt lgkmcnt(3)
    v_dot2_f32_bf16 v176, v64, s54, v176
    v_dot2_f32_bf16 v177, v64, v64, v177
    v_dot2_f32_bf16 v178, v65, s54, v178
    v_dot2_f32_bf16 v179, v65, v65, v179
    v_dot2_f32_bf16 v176, v66, s54, v176
    v_dot2_f32_bf16 v177, v66, v66, v177
    v_dot2_f32_bf16 v178, v67, s54, v178
    v_dot2_f32_bf16 v179, v67, v67, v179
    s_waitcnt lgkmcnt(2)
    v_dot2_f32_bf16 v176, v68, s54, v176
    v_dot2_f32_bf16 v177, v68, v68, v177
    v_dot2_f32_bf16 v178, v69, s54, v178
    v_dot2_f32_bf16 v179, v69, v69, v179
    v_dot2_f32_bf16 v176, v70, s54, v176
    v_dot2_f32_bf16 v177, v70, v70, v177
    v_dot2_f32_bf16 v178, v71, s54, v178
    v_dot2_f32_bf16 v179, v71, v71, v179
    s_waitcnt lgkmcnt(1)
    v_dot2_f32_bf16 v176, v72, s54, v176
    v_dot2_f32_bf16 v177, v72, v72, v177
    v_dot2_f32_bf16 v178, v73, s54, v178
    v_dot2_f32_bf16 v179, v73, v73, v179
    v_dot2_f32_bf16 v176, v74, s54, v176
    v_dot2_f32_bf16 v177, v74, v74, v177
    v_dot2_f32_bf16 v178, v75, s54, v178
    v_dot2_f32_bf16 v179, v75, v75, v179
    s_waitcnt lgkmcnt(0)
    s_add_u32 m0, s58, 8192
    s_add_u32 s53, s98, 0
    buffer_load_dwordx4 v224, s[8:11], s53 offen lds
    s_add_u32 m0, s58, 9216
    s_add_u32 s53, s98, 7168
    buffer_load_dwordx4 v225, s[8:11], s53 offen lds
    s_add_u32 m0, s58, 10240
    s_add_u32 s53, s98, 14336
    buffer_load_dwordx4 v224, s[8:11], s53 offen lds
    s_add_u32 m0, s58, 11264
    s_add_u32 s53, s98, 21504
    buffer_load_dwordx4 v225, s[8:11], s53 offen lds
    s_add_u32 s98, s98, 128
    s_cmp_eq_u32 s98, s99
    s_cselect_b32 s98, s94, s98
    v_dot2_f32_bf16 v176, v76, s54, v176
    v_dot2_f32_bf16 v177, v76, v76, v177
    v_dot2_f32_bf16 v178, v77, s54, v178
    v_dot2_f32_bf16 v179, v77, v77, v179
    v_dot2_f32_bf16 v176, v78, s54, v176
    v_dot2_f32_bf16 v177, v78, v78, v177
    v_dot2_f32_bf16 v178, v79, s54, v178
    v_dot2_f32_bf16 v179, v79, v79, v179
    s_waitcnt vmcnt(12)
    ds_read_b128 v[80:83], v226 offset:12288
    ds_read_b128 v[84:87], v227 offset:12288
    ds_read_b128 v[88:91], v228 offset:12288
    ds_read_b128 v[92:95], v229 offset:12288
    s_waitcnt lgkmcnt(3)
    v_dot2_f32_bf16 v176, v80, s54, v176
    v_dot2_f32_bf16 v177, v80, v80, v177
    v_dot2_f32_bf16 v178, v81, s54, v178
    v_dot2_f32_bf16 v179, v81, v81, v179
    v_dot2_f32_bf16 v176, v82, s54, v176
    v_dot2_f32_bf16 v177, v82, v82, v177
    v_dot2_f32_bf16 v178, v83, s54, v178
    v_dot2_f32_bf16 v179, v83, v83, v179
    s_waitcnt lgkmcnt(2)
    v_dot2_f32_bf16 v176, v84, s54, v176
    v_dot2_f32_bf16 v177, v84, v84, v177
    v_dot2_f32_bf16 v178, v85, s54, v178
    v_dot2_f32_bf16 v179, v85, v85, v179
    v_dot2_f32_bf16 v176, v86, s54, v176
    v_dot2_f32_bf16 v177, v86, v86, v177
    v_dot2_f32_bf16 v178, v87, s54, v178
    v_dot2_f32_bf16 v179, v87, v87, v179
    s_waitcnt lgkmcnt(1)
    v_dot2_f32_bf16 v176, v88, s54, v176
    v_dot2_f32_bf16 v177, v88, v88, v177
    v_dot2_f32_bf16 v178, v89, s54, v178
    v_dot2_f32_bf16 v179, v89, v89, v179
    v_dot2_f32_bf16 v176, v90, s54, v176
    v_dot2_f32_bf16 v177, v90, v90, v177
    v_dot2_f32_bf16 v178, v91, s54, v178
    v_dot2_f32_bf16 v179, v91, v91, v179
    s_waitcnt lgkmcnt(0)
    v_dot2_f32_bf16 v176, v92, s54, v176
    v_dot2_f32_bf16 v177, v92, v92, v177
    v_dot2_f32_bf16 v178, v93, s54, v178
    v_dot2_f32_bf16 v179, v93, v93, v179
    v_dot2_f32_bf16 v176, v94, s54, v176
    v_dot2_f32_bf16 v177, v94, v94, v177
    v_dot2_f32_bf16 v178, v95, s54, v178
    v_dot2_f32_bf16 v179, v95, v95, v179
    s_mul_i32 s53, s49, 28672
    s_lshl_b32 s55, s50, 6
    s_add_u32 s53, s53, s55
    buffer_load_dwordx4 v[24:27], v7, s[8:11], s53 offen
    buffer_load_dwordx4 v[28:31], v7, s[8:11], s53 offen offset:32
    s_lshl_b32 s55, s48, 4
    s_add_u32 s55, s55, s42
    s_lshl_b32 s55, s55, 11
    s_add_u32 s55, s55, 0x01200000
    buffer_store_dwordx4 v[180:183], v2, s[28:31], s55 offen offset:0 sc1
    buffer_store_dwordx4 v[180:183], v2, s[28:31], s55 offen offset:1024 sc1
    s_lshl_b32 s55, s7, 11
    s_and_b32 s82, s40, 1
    s_lshl_b32 s82, s82, 10
    s_add_u32 s55, s55, s82
    s_add_u32 s55, s55, 0x01400000
    buffer_store_dwordx4 v[180:183], v2, s[28:31], s55 offen offset:0 sc1
    s_waitcnt vmcnt(13)
    ds_read_b128 v[96:99], v226 offset:0
    ds_read_b128 v[100:103], v227 offset:0
    ds_read_b128 v[104:107], v228 offset:0
    ds_read_b128 v[108:111], v229 offset:0
    s_waitcnt lgkmcnt(3)
    v_dot2_f32_bf16 v176, v96, s54, v176
    v_dot2_f32_bf16 v177, v96, v96, v177
    v_dot2_f32_bf16 v178, v97, s54, v178
    v_dot2_f32_bf16 v179, v97, v97, v179
    v_dot2_f32_bf16 v176, v98, s54, v176
    v_dot2_f32_bf16 v177, v98, v98, v177
    v_dot2_f32_bf16 v178, v99, s54, v178
    v_dot2_f32_bf16 v179, v99, v99, v179
    s_waitcnt lgkmcnt(2)
    v_dot2_f32_bf16 v176, v100, s54, v176
    v_dot2_f32_bf16 v177, v100, v100, v177
    v_dot2_f32_bf16 v178, v101, s54, v178
    v_dot2_f32_bf16 v179, v101, v101, v179
    v_dot2_f32_bf16 v176, v102, s54, v176
    v_dot2_f32_bf16 v177, v102, v102, v177
    v_dot2_f32_bf16 v178, v103, s54, v178
    v_dot2_f32_bf16 v179, v103, v103, v179
    s_waitcnt lgkmcnt(1)
    v_dot2_f32_bf16 v176, v104, s54, v176
    v_dot2_f32_bf16 v177, v104, v104, v177
    v_dot2_f32_bf16 v178, v105, s54, v178
    v_dot2_f32_bf16 v179, v105, v105, v179
    v_dot2_f32_bf16 v176, v106, s54, v176
    v_dot2_f32_bf16 v177, v106, v106, v177
    v_dot2_f32_bf16 v178, v107, s54, v178
    v_dot2_f32_bf16 v179, v107, v107, v179
    s_waitcnt lgkmcnt(0)
    v_dot2_f32_bf16 v176, v108, s54, v176
    v_dot2_f32_bf16 v177, v108, v108, v177
    v_dot2_f32_bf16 v178, v109, s54, v178
    v_dot2_f32_bf16 v179, v109, v109, v179
    v_dot2_f32_bf16 v176, v110, s54, v176
    v_dot2_f32_bf16 v177, v110, v110, v177
    v_dot2_f32_bf16 v178, v111, s54, v178
    v_dot2_f32_bf16 v179, v111, v111, v179
    s_waitcnt vmcnt(9)
    ds_read_b128 v[112:115], v226 offset:4096
    ds_read_b128 v[116:119], v227 offset:4096
    ds_read_b128 v[120:123], v228 offset:4096
    ds_read_b128 v[124:127], v229 offset:4096
    s_waitcnt lgkmcnt(3)
    v_dot2_f32_bf16 v176, v112, s54, v176
    v_dot2_f32_bf16 v177, v112, v112, v177
    v_dot2_f32_bf16 v178, v113, s54, v178
    v_dot2_f32_bf16 v179, v113, v113, v179
    v_dot2_f32_bf16 v176, v114, s54, v176
    v_dot2_f32_bf16 v177, v114, v114, v177
    v_dot2_f32_bf16 v178, v115, s54, v178
    v_dot2_f32_bf16 v179, v115, v115, v179
    s_waitcnt lgkmcnt(2)
    v_dot2_f32_bf16 v176, v116, s54, v176
    v_dot2_f32_bf16 v177, v116, v116, v177
    v_dot2_f32_bf16 v178, v117, s54, v178
    v_dot2_f32_bf16 v179, v117, v117, v179
    v_dot2_f32_bf16 v176, v118, s54, v176
    v_dot2_f32_bf16 v177, v118, v118, v177
    v_dot2_f32_bf16 v178, v119, s54, v178
    v_dot2_f32_bf16 v179, v119, v119, v179
    s_waitcnt lgkmcnt(1)
    v_dot2_f32_bf16 v176, v120, s54, v176
    v_dot2_f32_bf16 v177, v120, v120, v177
    v_dot2_f32_bf16 v178, v121, s54, v178
    v_dot2_f32_bf16 v179, v121, v121, v179
    v_dot2_f32_bf16 v176, v122, s54, v176
    v_dot2_f32_bf16 v177, v122, v122, v177
    v_dot2_f32_bf16 v178, v123, s54, v178
    v_dot2_f32_bf16 v179, v123, v123, v179
    s_waitcnt lgkmcnt(0)
    v_dot2_f32_bf16 v176, v124, s54, v176
    v_dot2_f32_bf16 v177, v124, v124, v177
    v_dot2_f32_bf16 v178, v125, s54, v178
    v_dot2_f32_bf16 v179, v125, v125, v179
    v_dot2_f32_bf16 v176, v126, s54, v176
    v_dot2_f32_bf16 v177, v126, v126, v177
    v_dot2_f32_bf16 v178, v127, s54, v178
    v_dot2_f32_bf16 v179, v127, v127, v179
    s_waitcnt vmcnt(5)
    ds_read_b128 v[128:131], v226 offset:8192
    ds_read_b128 v[132:135], v227 offset:8192
    ds_read_b128 v[136:139], v228 offset:8192
    ds_read_b128 v[140:143], v229 offset:8192
    s_waitcnt lgkmcnt(3)
    v_dot2_f32_bf16 v176, v128, s54, v176
    v_dot2_f32_bf16 v177, v128, v128, v177
    v_dot2_f32_bf16 v178, v129, s54, v178
    v_dot2_f32_bf16 v179, v129, v129, v179
    v_dot2_f32_bf16 v176, v130, s54, v176
    v_dot2_f32_bf16 v177, v130, v130, v177
    v_dot2_f32_bf16 v178, v131, s54, v178
    v_dot2_f32_bf16 v179, v131, v131, v179
    s_waitcnt lgkmcnt(2)
    v_dot2_f32_bf16 v176, v132, s54, v176
    v_dot2_f32_bf16 v177, v132, v132, v177
    v_dot2_f32_bf16 v178, v133, s54, v178
    v_dot2_f32_bf16 v179, v133, v133, v179
    v_dot2_f32_bf16 v176, v134, s54, v176
    v_dot2_f32_bf16 v177, v134, v134, v177
    v_dot2_f32_bf16 v178, v135, s54, v178
    v_dot2_f32_bf16 v179, v135, v135, v179
    s_waitcnt lgkmcnt(1)
    v_dot2_f32_bf16 v176, v136, s54, v176
    v_dot2_f32_bf16 v177, v136, v136, v177
    v_dot2_f32_bf16 v178, v137, s54, v178
    v_dot2_f32_bf16 v179, v137, v137, v179
    v_dot2_f32_bf16 v176, v138, s54, v176
    v_dot2_f32_bf16 v177, v138, v138, v177
    v_dot2_f32_bf16 v178, v139, s54, v178
    v_dot2_f32_bf16 v179, v139, v139, v179
    s_waitcnt lgkmcnt(0)
    v_dot2_f32_bf16 v176, v140, s54, v176
    v_dot2_f32_bf16 v177, v140, v140, v177
    v_dot2_f32_bf16 v178, v141, s54, v178
    v_dot2_f32_bf16 v179, v141, v141, v179
    v_dot2_f32_bf16 v176, v142, s54, v176
    v_dot2_f32_bf16 v177, v142, v142, v177
    v_dot2_f32_bf16 v178, v143, s54, v178
    v_dot2_f32_bf16 v179, v143, v143, v179
    s_nop 2
    v_pk_add_f32 v[176:177], v[176:177], v[178:179]
    v_mov_b32 v14, v176
    v_mov_b32 v15, v177
    s_nop 0
    v_permlane32_swap_b32 v14, v176
    v_permlane32_swap_b32 v15, v177
    v_add_f32 v176, v176, v14
    v_add_f32 v177, v177, v15
    v_mul_f32 v11, 0xbb124925, v176
    v_mul_f32 v177, 0x3b124925, v177
    v_fma_f32 v177, -v11, v11, v177
    v_and_b32 v177, 0x7fffffff, v177
    v_add_f32 v177, 0x3727c5ac, v177
    v_rsq_f32 v10, v177
    s_lshl_b32 s53, s40, 8
    s_add_u32 s53, s53, 162560
    v_and_b32 v14, 31, v1
    v_lshl_add_u32 v14, v14, 2, s53
    v_lshrrev_b32 v15, 5, v1
    v_lshl_add_u32 v15, v15, 4, s53
    ds_write_b32 v14, v10
    ds_write_b32 v14, v11 offset:128
    ds_read_b128 v[208:211], v15 offset:0
    ds_read_b128 v[212:215], v15 offset:32
    ds_read_b128 v[216:219], v15 offset:64
    ds_read_b128 v[220:223], v15 offset:96
    ds_read_b128 v[224:227], v15 offset:128
    ds_read_b128 v[228:231], v15 offset:160
    ds_read_b128 v[232:235], v15 offset:192
    ds_read_b128 v[236:239], v15 offset:224
    s_waitcnt lgkmcnt(0)
    s_barrier
    ds_read_b64_tr_b16 v[192:193], v3 offset:0
    ds_read_b64_tr_b16 v[194:195], v3 offset:512
    ds_read_b64_tr_b16 v[196:197], v4 offset:0
    ds_read_b64_tr_b16 v[198:199], v4 offset:512
    ds_read_b64_tr_b16 v[200:201], v3 offset:2048
    ds_read_b64_tr_b16 v[202:203], v3 offset:2560
    ds_read_b64_tr_b16 v[204:205], v4 offset:2048
    ds_read_b64_tr_b16 v[206:207], v4 offset:2560
    ds_read_b64_tr_b16 v[240:241], v3 offset:4096
    ds_read_b64_tr_b16 v[242:243], v3 offset:4608
    ds_read_b64_tr_b16 v[244:245], v4 offset:4096
    ds_read_b64_tr_b16 v[246:247], v4 offset:4608
    s_waitcnt lgkmcnt(8)
    v_mfma_f32_32x32x16_bf16 v[144:159], v[32:35], v[192:195], 0
    v_mfma_f32_32x32x16_bf16 v[160:175], v[32:35], v[196:199], 0
    ds_read_b64_tr_b16 v[248:249], v3 offset:6144
    ds_read_b64_tr_b16 v[250:251], v3 offset:6656
    ds_read_b64_tr_b16 v[252:253], v4 offset:6144
    ds_read_b64_tr_b16 v[254:255], v4 offset:6656
    s_waitcnt lgkmcnt(8)
    v_mfma_f32_32x32x16_bf16 v[144:159], v[36:39], v[200:203], v[144:159]
    v_mfma_f32_32x32x16_bf16 v[160:175], v[36:39], v[204:207], v[160:175]
    ds_read_b64_tr_b16 v[192:193], v3 offset:8192
    ds_read_b64_tr_b16 v[194:195], v3 offset:8704
    ds_read_b64_tr_b16 v[196:197], v4 offset:8192
    ds_read_b64_tr_b16 v[198:199], v4 offset:8704
    s_waitcnt lgkmcnt(8)
    v_mfma_f32_32x32x16_bf16 v[144:159], v[40:43], v[240:243], v[144:159]
    v_mfma_f32_32x32x16_bf16 v[160:175], v[40:43], v[244:247], v[160:175]
    ds_read_b64_tr_b16 v[200:201], v3 offset:10240
    ds_read_b64_tr_b16 v[202:203], v3 offset:10752
    ds_read_b64_tr_b16 v[204:205], v4 offset:10240
    ds_read_b64_tr_b16 v[206:207], v4 offset:10752
    s_waitcnt lgkmcnt(8)
    v_mfma_f32_32x32x16_bf16 v[144:159], v[44:47], v[248:251], v[144:159]
    v_mfma_f32_32x32x16_bf16 v[160:175], v[44:47], v[252:255], v[160:175]
    ds_read_b64_tr_b16 v[240:241], v3 offset:12288
    ds_read_b64_tr_b16 v[242:243], v3 offset:12800
    ds_read_b64_tr_b16 v[244:245], v4 offset:12288
    ds_read_b64_tr_b16 v[246:247], v4 offset:12800
    s_waitcnt lgkmcnt(8)
    v_mfma_f32_32x32x16_bf16 v[144:159], v[48:51], v[192:195], v[144:159]
    v_mfma_f32_32x32x16_bf16 v[160:175], v[48:51], v[196:199], v[160:175]
    ds_read_b64_tr_b16 v[248:249], v3 offset:14336
    ds_read_b64_tr_b16 v[250:251], v3 offset:14848
    ds_read_b64_tr_b16 v[252:253], v4 offset:14336
    ds_read_b64_tr_b16 v[254:255], v4 offset:14848
    s_waitcnt lgkmcnt(8)
    v_mfma_f32_32x32x16_bf16 v[144:159], v[52:55], v[200:203], v[144:159]
    v_mfma_f32_32x32x16_bf16 v[160:175], v[52:55], v[204:207], v[160:175]
    s_waitcnt lgkmcnt(4)
    v_mfma_f32_32x32x16_bf16 v[144:159], v[56:59], v[240:243], v[144:159]
    v_mfma_f32_32x32x16_bf16 v[160:175], v[56:59], v[244:247], v[160:175]
    s_waitcnt lgkmcnt(0)
    v_mfma_f32_32x32x16_bf16 v[144:159], v[60:63], v[248:251], v[144:159]
    v_mfma_f32_32x32x16_bf16 v[160:175], v[60:63], v[252:255], v[160:175]
    s_barrier
    ds_read_b64_tr_b16 v[192:193], v3 offset:16384
    ds_read_b64_tr_b16 v[194:195], v3 offset:16896
    ds_read_b64_tr_b16 v[196:197], v4 offset:16384
    ds_read_b64_tr_b16 v[198:199], v4 offset:16896
    ds_read_b64_tr_b16 v[200:201], v3 offset:18432
    ds_read_b64_tr_b16 v[202:203], v3 offset:18944
    ds_read_b64_tr_b16 v[204:205], v4 offset:18432
    ds_read_b64_tr_b16 v[206:207], v4 offset:18944
    ds_read_b64_tr_b16 v[240:241], v3 offset:20480
    ds_read_b64_tr_b16 v[242:243], v3 offset:20992
    ds_read_b64_tr_b16 v[244:245], v4 offset:20480
    ds_read_b64_tr_b16 v[246:247], v4 offset:20992
    s_waitcnt lgkmcnt(8)
    v_mfma_f32_32x32x16_bf16 v[144:159], v[64:67], v[192:195], v[144:159]
    v_mfma_f32_32x32x16_bf16 v[160:175], v[64:67], v[196:199], v[160:175]
    ds_read_b64_tr_b16 v[248:249], v3 offset:22528
    ds_read_b64_tr_b16 v[250:251], v3 offset:23040
    ds_read_b64_tr_b16 v[252:253], v4 offset:22528
    ds_read_b64_tr_b16 v[254:255], v4 offset:23040
    s_waitcnt lgkmcnt(8)
    v_mfma_f32_32x32x16_bf16 v[144:159], v[68:71], v[200:203], v[144:159]
    v_mfma_f32_32x32x16_bf16 v[160:175], v[68:71], v[204:207], v[160:175]
    ds_read_b64_tr_b16 v[192:193], v3 offset:24576
    ds_read_b64_tr_b16 v[194:195], v3 offset:25088
    ds_read_b64_tr_b16 v[196:197], v4 offset:24576
    ds_read_b64_tr_b16 v[198:199], v4 offset:25088
    s_waitcnt lgkmcnt(8)
    v_mfma_f32_32x32x16_bf16 v[144:159], v[72:75], v[240:243], v[144:159]
    v_mfma_f32_32x32x16_bf16 v[160:175], v[72:75], v[244:247], v[160:175]
    ds_read_b64_tr_b16 v[200:201], v3 offset:26624
    ds_read_b64_tr_b16 v[202:203], v3 offset:27136
    ds_read_b64_tr_b16 v[204:205], v4 offset:26624
    ds_read_b64_tr_b16 v[206:207], v4 offset:27136
    s_waitcnt lgkmcnt(8)
    v_mfma_f32_32x32x16_bf16 v[144:159], v[76:79], v[248:251], v[144:159]
    v_mfma_f32_32x32x16_bf16 v[160:175], v[76:79], v[252:255], v[160:175]
    ds_read_b64_tr_b16 v[240:241], v3 offset:28672
    ds_read_b64_tr_b16 v[242:243], v3 offset:29184
    ds_read_b64_tr_b16 v[244:245], v4 offset:28672
    ds_read_b64_tr_b16 v[246:247], v4 offset:29184
    s_waitcnt lgkmcnt(8)
    v_mfma_f32_32x32x16_bf16 v[144:159], v[80:83], v[192:195], v[144:159]
    v_mfma_f32_32x32x16_bf16 v[160:175], v[80:83], v[196:199], v[160:175]
    ds_read_b64_tr_b16 v[248:249], v3 offset:30720
    ds_read_b64_tr_b16 v[250:251], v3 offset:31232
    ds_read_b64_tr_b16 v[252:253], v4 offset:30720
    ds_read_b64_tr_b16 v[254:255], v4 offset:31232
    s_waitcnt lgkmcnt(8)
    v_mfma_f32_32x32x16_bf16 v[144:159], v[84:87], v[200:203], v[144:159]
    v_mfma_f32_32x32x16_bf16 v[160:175], v[84:87], v[204:207], v[160:175]
    s_waitcnt lgkmcnt(4)
    v_mfma_f32_32x32x16_bf16 v[144:159], v[88:91], v[240:243], v[144:159]
    v_mfma_f32_32x32x16_bf16 v[160:175], v[88:91], v[244:247], v[160:175]
    s_waitcnt lgkmcnt(0)
    v_mfma_f32_32x32x16_bf16 v[144:159], v[92:95], v[248:251], v[144:159]
    v_mfma_f32_32x32x16_bf16 v[160:175], v[92:95], v[252:255], v[160:175]
    s_barrier
    ds_read_b64_tr_b16 v[192:193], v3 offset:32768
    ds_read_b64_tr_b16 v[194:195], v3 offset:33280
    ds_read_b64_tr_b16 v[196:197], v4 offset:32768
    ds_read_b64_tr_b16 v[198:199], v4 offset:33280
    ds_read_b64_tr_b16 v[200:201], v3 offset:34816
    ds_read_b64_tr_b16 v[202:203], v3 offset:35328
    ds_read_b64_tr_b16 v[204:205], v4 offset:34816
    ds_read_b64_tr_b16 v[206:207], v4 offset:35328
    ds_read_b64_tr_b16 v[240:241], v3 offset:36864
    ds_read_b64_tr_b16 v[242:243], v3 offset:37376
    ds_read_b64_tr_b16 v[244:245], v4 offset:36864
    ds_read_b64_tr_b16 v[246:247], v4 offset:37376
    s_waitcnt lgkmcnt(8)
    v_mfma_f32_32x32x16_bf16 v[144:159], v[96:99], v[192:195], v[144:159]
    v_mfma_f32_32x32x16_bf16 v[160:175], v[96:99], v[196:199], v[160:175]
    ds_read_b64_tr_b16 v[248:249], v3 offset:38912
    ds_read_b64_tr_b16 v[250:251], v3 offset:39424
    ds_read_b64_tr_b16 v[252:253], v4 offset:38912
    ds_read_b64_tr_b16 v[254:255], v4 offset:39424
    s_waitcnt lgkmcnt(8)
    v_mfma_f32_32x32x16_bf16 v[144:159], v[100:103], v[200:203], v[144:159]
    v_mfma_f32_32x32x16_bf16 v[160:175], v[100:103], v[204:207], v[160:175]
    ds_read_b64_tr_b16 v[192:193], v3 offset:40960
    ds_read_b64_tr_b16 v[194:195], v3 offset:41472
    ds_read_b64_tr_b16 v[196:197], v4 offset:40960
    ds_read_b64_tr_b16 v[198:199], v4 offset:41472
    s_waitcnt lgkmcnt(8)
    v_mfma_f32_32x32x16_bf16 v[144:159], v[104:107], v[240:243], v[144:159]
    v_mfma_f32_32x32x16_bf16 v[160:175], v[104:107], v[244:247], v[160:175]
    ds_read_b64_tr_b16 v[200:201], v3 offset:43008
    ds_read_b64_tr_b16 v[202:203], v3 offset:43520
    ds_read_b64_tr_b16 v[204:205], v4 offset:43008
    ds_read_b64_tr_b16 v[206:207], v4 offset:43520
    s_waitcnt lgkmcnt(8)
    v_mfma_f32_32x32x16_bf16 v[144:159], v[108:111], v[248:251], v[144:159]
    v_mfma_f32_32x32x16_bf16 v[160:175], v[108:111], v[252:255], v[160:175]
    ds_read_b64_tr_b16 v[240:241], v3 offset:45056
    ds_read_b64_tr_b16 v[242:243], v3 offset:45568
    ds_read_b64_tr_b16 v[244:245], v4 offset:45056
    ds_read_b64_tr_b16 v[246:247], v4 offset:45568
    s_waitcnt lgkmcnt(8)
    v_mfma_f32_32x32x16_bf16 v[144:159], v[112:115], v[192:195], v[144:159]
    v_mfma_f32_32x32x16_bf16 v[160:175], v[112:115], v[196:199], v[160:175]
    ds_read_b64_tr_b16 v[248:249], v3 offset:47104
    ds_read_b64_tr_b16 v[250:251], v3 offset:47616
    ds_read_b64_tr_b16 v[252:253], v4 offset:47104
    ds_read_b64_tr_b16 v[254:255], v4 offset:47616
    s_waitcnt lgkmcnt(8)
    v_mfma_f32_32x32x16_bf16 v[144:159], v[116:119], v[200:203], v[144:159]
    v_mfma_f32_32x32x16_bf16 v[160:175], v[116:119], v[204:207], v[160:175]
    ds_read_b64_tr_b16 v[192:193], v3 offset:49152
    ds_read_b64_tr_b16 v[194:195], v3 offset:49664
    ds_read_b64_tr_b16 v[196:197], v4 offset:49152
    ds_read_b64_tr_b16 v[198:199], v4 offset:49664
    s_waitcnt lgkmcnt(8)
    v_mfma_f32_32x32x16_bf16 v[144:159], v[120:123], v[240:243], v[144:159]
    v_mfma_f32_32x32x16_bf16 v[160:175], v[120:123], v[244:247], v[160:175]
    ds_read_b64_tr_b16 v[200:201], v3 offset:51200
    ds_read_b64_tr_b16 v[202:203], v3 offset:51712
    ds_read_b64_tr_b16 v[204:205], v4 offset:51200
    ds_read_b64_tr_b16 v[206:207], v4 offset:51712
    s_waitcnt lgkmcnt(8)
    v_mfma_f32_32x32x16_bf16 v[144:159], v[124:127], v[248:251], v[144:159]
    v_mfma_f32_32x32x16_bf16 v[160:175], v[124:127], v[252:255], v[160:175]
    ds_read_b64_tr_b16 v[240:241], v3 offset:53248
    ds_read_b64_tr_b16 v[242:243], v3 offset:53760
    ds_read_b64_tr_b16 v[244:245], v4 offset:53248
    ds_read_b64_tr_b16 v[246:247], v4 offset:53760
    s_waitcnt lgkmcnt(8)
    v_mfma_f32_32x32x16_bf16 v[144:159], v[128:131], v[192:195], v[144:159]
    v_mfma_f32_32x32x16_bf16 v[160:175], v[128:131], v[196:199], v[160:175]
    ds_read_b64_tr_b16 v[248:249], v3 offset:55296
    ds_read_b64_tr_b16 v[250:251], v3 offset:55808
    ds_read_b64_tr_b16 v[252:253], v4 offset:55296
    ds_read_b64_tr_b16 v[254:255], v4 offset:55808
    s_waitcnt lgkmcnt(8)
    v_mfma_f32_32x32x16_bf16 v[144:159], v[132:135], v[200:203], v[144:159]
    v_mfma_f32_32x32x16_bf16 v[160:175], v[132:135], v[204:207], v[160:175]
    s_waitcnt lgkmcnt(4)
    v_mfma_f32_32x32x16_bf16 v[144:159], v[136:139], v[240:243], v[144:159]
    v_mfma_f32_32x32x16_bf16 v[160:175], v[136:139], v[244:247], v[160:175]
    s_waitcnt lgkmcnt(0)
    v_mfma_f32_32x32x16_bf16 v[144:159], v[140:143], v[248:251], v[144:159]
    v_mfma_f32_32x32x16_bf16 v[160:175], v[140:143], v[252:255], v[160:175]
    s_barrier
    v_and_b32 v14, 31, v1
    v_lshlrev_b32 v14, 2, v14
    v_add_u32 v14, 160768, v14
    ds_read2_b32 v[176:177], v14 offset0:0 offset1:64
    ds_read2_b32 v[178:179], v14 offset0:32 offset1:96
    s_waitcnt lgkmcnt(0)
    v_add_f32 v12, v176, v177
    v_add_f32 v13, v178, v179
L_A_epi:
    s_nop 7
    v_pk_fma_f32 v[144:145], v[224:225], v[12:13], v[144:145] op_sel:[0,0,0] op_sel_hi:[1,0,1]
    v_pk_fma_f32 v[146:147], v[226:227], v[12:13], v[146:147] op_sel:[0,0,0] op_sel_hi:[1,0,1]
    v_pk_fma_f32 v[148:149], v[228:229], v[12:13], v[148:149] op_sel:[0,0,0] op_sel_hi:[1,0,1]
    v_pk_fma_f32 v[150:151], v[230:231], v[12:13], v[150:151] op_sel:[0,0,0] op_sel_hi:[1,0,1]
    v_pk_fma_f32 v[152:153], v[232:233], v[12:13], v[152:153] op_sel:[0,0,0] op_sel_hi:[1,0,1]
    v_pk_fma_f32 v[154:155], v[234:235], v[12:13], v[154:155] op_sel:[0,0,0] op_sel_hi:[1,0,1]
    v_pk_fma_f32 v[156:157], v[236:237], v[12:13], v[156:157] op_sel:[0,0,0] op_sel_hi:[1,0,1]
    v_pk_fma_f32 v[158:159], v[238:239], v[12:13], v[158:159] op_sel:[0,0,0] op_sel_hi:[1,0,1]
    v_pk_fma_f32 v[160:161], v[224:225], v[12:13], v[160:161] op_sel:[0,1,0] op_sel_hi:[1,1,1]
    v_pk_fma_f32 v[162:163], v[226:227], v[12:13], v[162:163] op_sel:[0,1,0] op_sel_hi:[1,1,1]
    v_pk_fma_f32 v[164:165], v[228:229], v[12:13], v[164:165] op_sel:[0,1,0] op_sel_hi:[1,1,1]
    v_pk_fma_f32 v[166:167], v[230:231], v[12:13], v[166:167] op_sel:[0,1,0] op_sel_hi:[1,1,1]
    v_pk_fma_f32 v[168:169], v[232:233], v[12:13], v[168:169] op_sel:[0,1,0] op_sel_hi:[1,1,1]
    v_pk_fma_f32 v[170:171], v[234:235], v[12:13], v[170:171] op_sel:[0,1,0] op_sel_hi:[1,1,1]
    v_pk_fma_f32 v[172:173], v[236:237], v[12:13], v[172:173] op_sel:[0,1,0] op_sel_hi:[1,1,1]
    v_pk_fma_f32 v[174:175], v[238:239], v[12:13], v[174:175] op_sel:[0,1,0] op_sel_hi:[1,1,1]
    v_pk_fma_f32 v[144:145], v[144:145], v[208:209], s[62:63] op_sel:[0,0,1] op_sel_hi:[1,1,1]
    v_pk_fma_f32 v[146:147], v[146:147], v[210:211], s[62:63] op_sel:[0,0,1] op_sel_hi:[1,1,1]
    v_pk_fma_f32 v[148:149], v[148:149], v[212:213], s[62:63] op_sel:[0,0,1] op_sel_hi:[1,1,1]
    v_pk_fma_f32 v[150:151], v[150:151], v[214:215], s[62:63] op_sel:[0,0,1] op_sel_hi:[1,1,1]
    v_pk_fma_f32 v[152:153], v[152:153], v[216:217], s[62:63] op_sel:[0,0,1] op_sel_hi:[1,1,1]
    v_pk_fma_f32 v[154:155], v[154:155], v[218:219], s[62:63] op_sel:[0,0,1] op_sel_hi:[1,1,1]
    v_pk_fma_f32 v[156:157], v[156:157], v[220:221], s[62:63] op_sel:[0,0,1] op_sel_hi:[1,1,1]
    v_pk_fma_f32 v[158:159], v[158:159], v[222:223], s[62:63] op_sel:[0,0,1] op_sel_hi:[1,1,1]
    v_pk_mul_f32 v[160:161], v[160:161], v[208:209]
    v_pk_mul_f32 v[162:163], v[162:163], v[210:211]
    v_pk_mul_f32 v[164:165], v[164:165], v[212:213]
    v_pk_mul_f32 v[166:167], v[166:167], v[214:215]
    v_pk_mul_f32 v[168:169], v[168:169], v[216:217]
    v_pk_mul_f32 v[170:171], v[170:171], v[218:219]
    v_pk_mul_f32 v[172:173], v[172:173], v[220:221]
    v_pk_mul_f32 v[174:175], v[174:175], v[222:223]
    v_cvt_pk_bf16_f32 v200, v160, v161
    v_cvt_pk_bf16_f32 v201, v162, v163
    v_cvt_pk_bf16_f32 v202, v164, v165
    v_cvt_pk_bf16_f32 v203, v166, v167
    v_cvt_pk_bf16_f32 v204, v168, v169
    v_cvt_pk_bf16_f32 v205, v170, v171
    v_cvt_pk_bf16_f32 v206, v172, v173
    v_cvt_pk_bf16_f32 v207, v174, v175
    v_cndmask_b32 v200, v200, v9, s[60:61]
    v_cndmask_b32 v201, v201, v9, s[60:61]
    v_cndmask_b32 v202, v202, v9, s[60:61]
    v_cndmask_b32 v203, v203, v9, s[60:61]
    v_cndmask_b32 v204, v204, v9, s[60:61]
    v_cndmask_b32 v205, v205, v9, s[60:61]
    v_cndmask_b32 v206, v206, v9, s[60:61]
    v_cndmask_b32 v207, v207, v9, s[60:61]
    v_pk_mul_f32 v[240:241], v[144:145], s[62:63] op_sel:[0,0] op_sel_hi:[1,0]
    v_pk_mul_f32 v[242:243], v[146:147], s[62:63] op_sel:[0,0] op_sel_hi:[1,0]
    v_pk_mul_f32 v[244:245], v[148:149], s[62:63] op_sel:[0,0] op_sel_hi:[1,0]
    v_pk_mul_f32 v[246:247], v[150:151], s[62:63] op_sel:[0,0] op_sel_hi:[1,0]
    v_pk_mul_f32 v[248:249], v[152:153], s[62:63] op_sel:[0,0] op_sel_hi:[1,0]
    v_pk_mul_f32 v[250:251], v[154:155], s[62:63] op_sel:[0,0] op_sel_hi:[1,0]
    v_pk_mul_f32 v[252:253], v[156:157], s[62:63] op_sel:[0,0] op_sel_hi:[1,0]
    v_pk_mul_f32 v[254:255], v[158:159], s[62:63] op_sel:[0,0] op_sel_hi:[1,0]
    v_exp_f32_e64 v240, v240 clamp
    v_max_f32 v144, s63, v144
    v_exp_f32_e64 v241, v241 clamp
    v_max_f32 v145, s63, v145
    v_exp_f32_e64 v242, v242 clamp
    v_max_f32 v146, s63, v146
    v_exp_f32_e64 v243, v243 clamp
    v_max_f32 v147, s63, v147
    v_exp_f32_e64 v244, v244 clamp
    v_max_f32 v148, s63, v148
    v_exp_f32_e64 v245, v245 clamp
    v_max_f32 v149, s63, v149
    v_exp_f32_e64 v246, v246 clamp
    v_max_f32 v150, s63, v150
    v_exp_f32_e64 v247, v247 clamp
    v_max_f32 v151, s63, v151
    v_exp_f32_e64 v248, v248 clamp
    v_max_f32 v152, s63, v152
    v_exp_f32_e64 v249, v249 clamp
    v_max_f32 v153, s63, v153
    v_exp_f32_e64 v250, v250 clamp
    v_max_f32 v154, s63, v154
    v_exp_f32_e64 v251, v251 clamp
    v_max_f32 v155, s63, v155
    v_exp_f32_e64 v252, v252 clamp
    v_max_f32 v156, s63, v156
    v_exp_f32_e64 v253, v253 clamp
    v_max_f32 v157, s63, v157
    v_exp_f32_e64 v254, v254 clamp
    v_max_f32 v158, s63, v158
    v_exp_f32_e64 v255, v255 clamp
    v_max_f32 v159, s63, v159
    v_pk_add_f32 v[144:145], v[144:145], v[240:241]
    v_pk_add_f32 v[146:147], v[146:147], v[242:243]
    v_pk_add_f32 v[148:149], v[148:149], v[244:245]
    v_pk_add_f32 v[150:151], v[150:151], v[246:247]
    v_pk_add_f32 v[152:153], v[152:153], v[248:249]
    v_pk_add_f32 v[154:155], v[154:155], v[250:251]
    v_pk_add_f32 v[156:157], v[156:157], v[252:253]
    v_pk_add_f32 v[158:159], v[158:159], v[254:255]
    v_cvt_pk_bf16_f32 v192, v144, v145
    v_cvt_pk_bf16_f32 v193, v146, v147
    v_cvt_pk_bf16_f32 v194, v148, v149
    v_cvt_pk_bf16_f32 v195, v150, v151
    v_cvt_pk_bf16_f32 v196, v152, v153
    v_cvt_pk_bf16_f32 v197, v154, v155
    v_cvt_pk_bf16_f32 v198, v156, v157
    v_cvt_pk_bf16_f32 v199, v158, v159
    v_mfma_f32_32x32x16_bf16 v[144:159], v[192:195], v[200:203], 0
    s_nop 0
    v_mfma_f32_32x32x16_bf16 v[144:159], v[196:199], v[204:207], v[144:159]
    s_lshl_b32 s53, s40, 12
    s_add_u32 s53, s53, 144384
    v_add_u32 v12, s53, v2
    s_lshl_b32 s53, s40, 11
    s_add_u32 s53, s53, 144384
    v_add_u32 v13, s53, v2
    s_lshl_b32 s55, s7, 11
    s_lshl_b32 s53, s40, 10
    s_add_u32 s55, s55, s53
    s_add_u32 s55, s55, s47
    s_add_u32 s55, s55, 0x00400000
    s_nop 0
    ds_write_b128 v12, v[144:147] offset:0
    ds_write_b128 v12, v[148:151] offset:1024
    ds_write_b128 v12, v[152:155] offset:2048
    ds_write_b128 v12, v[156:159] offset:3072
    v_cmp_u_f32 vcc, v144, v144
    s_nop 1
    s_cbranch_vccnz Lbad_119
Lok_120:
    s_waitcnt vmcnt(0) lgkmcnt(0)
    s_barrier
    s_cmp_ge_u32 s40, 2
    s_cbranch_scc1 L_A_q
    ds_read_b128 v[144:147], v13 offset:0
    ds_read_b128 v[148:151], v13 offset:1024
    ds_read_b128 v[152:155], v13 offset:4096
    ds_read_b128 v[156:159], v13 offset:5120
    ds_read_b128 v[160:163], v13 offset:8192
    ds_read_b128 v[164:167], v13 offset:9216
    ds_read_b128 v[168:171], v13 offset:12288
    ds_read_b128 v[172:175], v13 offset:13312
    s_waitcnt lgkmcnt(4)
    v_pk_add_f32 v[144:145], v[144:145], v[152:153]
    v_pk_add_f32 v[146:147], v[146:147], v[154:155]
    v_pk_add_f32 v[148:149], v[148:149], v[156:157]
    v_pk_add_f32 v[150:151], v[150:151], v[158:159]
    s_waitcnt lgkmcnt(2)
    v_pk_add_f32 v[144:145], v[144:145], v[160:161]
    v_pk_add_f32 v[146:147], v[146:147], v[162:163]
    v_pk_add_f32 v[148:149], v[148:149], v[164:165]
    v_pk_add_f32 v[150:151], v[150:151], v[166:167]
    s_waitcnt lgkmcnt(0)
    v_pk_add_f32 v[144:145], v[144:145], v[168:169]
    v_pk_add_f32 v[146:147], v[146:147], v[170:171]
    v_pk_add_f32 v[148:149], v[148:149], v[172:173]
    v_pk_add_f32 v[150:151], v[150:151], v[174:175]
    v_cvt_pk_bf16_f32 v152, v144, v145
    v_cvt_pk_bf16_f32 v153, v146, v147
    v_cvt_pk_bf16_f32 v154, v148, v149
    v_cvt_pk_bf16_f32 v155, v150, v151
    v_mov_b32 v14, 1
    buffer_store_dwordx4 v[152:155], v2, s[28:31], s55 offen sc1
L_A_q:
    ds_read_b64_tr_b16 v[192:193], v8 offset:0
    ds_read_b64_tr_b16 v[194:195], v8 offset:256
    ds_read_b64_tr_b16 v[196:197], v8 offset:1024
    ds_read_b64_tr_b16 v[198:199], v8 offset:1280
    ds_read_b64_tr_b16 v[200:201], v8 offset:2048
    ds_read_b64_tr_b16 v[202:203], v8 offset:2304
    ds_read_b64_tr_b16 v[204:205], v8 offset:3072
    ds_read_b64_tr_b16 v[206:207], v8 offset:3328
    s_waitcnt lgkmcnt(6)
    v_mfma_f32_32x32x16_bf16 v[176:191], v[192:195], v[32:35], 0
    ds_read_b64_tr_b16 v[192:193], v8 offset:4096
    ds_read_b64_tr_b16 v[194:195], v8 offset:4352
    s_waitcnt lgkmcnt(6)
    v_mfma_f32_32x32x16_bf16 v[176:191], v[196:199], v[36:39], v[176:191]
    v_lshrrev_b32 v12, 5, v1
    v_and_b32 v13, 31, v1
    v_lshlrev_b32 v12, 2, v12
    v_sub_u32 v13, v13, v12
    v_mov_b32 v168, 0x3f80
    v_mov_b32 v169, 0x3f800000
    ds_read_b64_tr_b16 v[196:197], v8 offset:5120
    ds_read_b64_tr_b16 v[198:199], v8 offset:5376
    s_waitcnt lgkmcnt(6)
    v_mfma_f32_32x32x16_bf16 v[176:191], v[200:203], v[40:43], v[176:191]
    ds_read_b64_tr_b16 v[200:201], v8 offset:6144
    ds_read_b64_tr_b16 v[202:203], v8 offset:6400
    s_waitcnt lgkmcnt(6)
    v_mfma_f32_32x32x16_bf16 v[176:191], v[204:207], v[44:47], v[176:191]
    v_cmp_eq_u32 vcc, 0, v13
    v_cmp_eq_u32 s[58:59], 1, v13
    s_nop 0
    v_cndmask_b32 v160, 0, v168, vcc
    v_cndmask_b32 v160, v160, v169, s[58:59]
    ds_read_b64_tr_b16 v[204:205], v8 offset:7168
    ds_read_b64_tr_b16 v[206:207], v8 offset:7424
    s_waitcnt lgkmcnt(6)
    v_mfma_f32_32x32x16_bf16 v[176:191], v[192:195], v[48:51], v[176:191]
    ds_read_b64_tr_b16 v[192:193], v8 offset:8192
    ds_read_b64_tr_b16 v[194:195], v8 offset:8448
    s_waitcnt lgkmcnt(6)
    v_mfma_f32_32x32x16_bf16 v[176:191], v[196:199], v[52:55], v[176:191]
    v_cmp_eq_u32 vcc, 2, v13
    v_cmp_eq_u32 s[58:59], 3, v13
    s_nop 0
    v_cndmask_b32 v161, 0, v168, vcc
    v_cndmask_b32 v161, v161, v169, s[58:59]
    ds_read_b64_tr_b16 v[196:197], v8 offset:9216
    ds_read_b64_tr_b16 v[198:199], v8 offset:9472
    s_waitcnt lgkmcnt(6)
    v_mfma_f32_32x32x16_bf16 v[176:191], v[200:203], v[56:59], v[176:191]
    ds_read_b64_tr_b16 v[200:201], v8 offset:10240
    ds_read_b64_tr_b16 v[202:203], v8 offset:10496
    s_waitcnt lgkmcnt(6)
    v_mfma_f32_32x32x16_bf16 v[176:191], v[204:207], v[60:63], v[176:191]
    v_cmp_eq_u32 vcc, 8, v13
    v_cmp_eq_u32 s[58:59], 9, v13
    s_nop 0
    v_cndmask_b32 v162, 0, v168, vcc
    v_cndmask_b32 v162, v162, v169, s[58:59]
    ds_read_b64_tr_b16 v[204:205], v8 offset:11264
    ds_read_b64_tr_b16 v[206:207], v8 offset:11520
    s_waitcnt lgkmcnt(6)
    v_mfma_f32_32x32x16_bf16 v[176:191], v[192:195], v[64:67], v[176:191]
    ds_read_b64_tr_b16 v[192:193], v8 offset:12288
    ds_read_b64_tr_b16 v[194:195], v8 offset:12544
    s_waitcnt lgkmcnt(6)
    v_mfma_f32_32x32x16_bf16 v[176:191], v[196:199], v[68:71], v[176:191]
    v_cmp_eq_u32 vcc, 10, v13
    v_cmp_eq_u32 s[58:59], 11, v13
    s_nop 0
    v_cndmask_b32 v163, 0, v168, vcc
    v_cndmask_b32 v163, v163, v169, s[58:59]
    ds_read_b64_tr_b16 v[196:197], v8 offset:13312
    ds_read_b64_tr_b16 v[198:199], v8 offset:13568
    s_waitcnt lgkmcnt(6)
    v_mfma_f32_32x32x16_bf16 v[176:191], v[200:203], v[72:75], v[176:191]
    ds_read_b64_tr_b16 v[200:201], v8 offset:14336
    ds_read_b64_tr_b16 v[202:203], v8 offset:14592
    s_waitcnt lgkmcnt(6)
    v_mfma_f32_32x32x16_bf16 v[176:191], v[204:207], v[76:79], v[176:191]
    v_cmp_eq_u32 vcc, 16, v13
    v_cmp_eq_u32 s[58:59], 17, v13
    s_nop 0
    v_cndmask_b32 v164, 0, v168, vcc
    v_cndmask_b32 v164, v164, v169, s[58:59]
    ds_read_b64_tr_b16 v[204:205], v8 offset:15360
    ds_read_b64_tr_b16 v[206:207], v8 offset:15616
    s_waitcnt lgkmcnt(6)
    v_mfma_f32_32x32x16_bf16 v[176:191], v[192:195], v[80:83], v[176:191]
    ds_read_b64_tr_b16 v[192:193], v8 offset:16384
    ds_read_b64_tr_b16 v[194:195], v8 offset:16640
    s_waitcnt lgkmcnt(6)
    v_mfma_f32_32x32x16_bf16 v[176:191], v[196:199], v[84:87], v[176:191]
    v_cmp_eq_u32 vcc, 18, v13
    v_cmp_eq_u32 s[58:59], 19, v13
    s_nop 0
    v_cndmask_b32 v165, 0, v168, vcc
    v_cndmask_b32 v165, v165, v169, s[58:59]
    ds_read_b64_tr_b16 v[196:197], v8 offset:17408
    ds_read_b64_tr_b16 v[198:199], v8 offset:17664
    s_waitcnt lgkmcnt(6)
    v_mfma_f32_32x32x16_bf16 v[176:191], v[200:203], v[88:91], v[176:191]
    ds_read_b64_tr_b16 v[200:201], v8 offset:18432
    ds_read_b64_tr_b16 v[202:203], v8 offset:18688
    s_waitcnt lgkmcnt(6)
    v_mfma_f32_32x32x16_bf16 v[176:191], v[204:207], v[92:95], v[176:191]
    v_cmp_eq_u32 vcc, 24, v13
    v_cmp_eq_u32 s[58:59], 25, v13
    s_nop 0
    v_cndmask_b32 v166, 0, v168, vcc
    v_cndmask_b32 v166, v166, v169, s[58:59]
    ds_read_b64_tr_b16 v[204:205], v8 offset:19456
    ds_read_b64_tr_b16 v[206:207], v8 offset:19712
    s_waitcnt lgkmcnt(6)
    v_mfma_f32_32x32x16_bf16 v[176:191], v[192:195], v[96:99], v[176:191]
    ds_read_b64_tr_b16 v[192:193], v8 offset:20480
    ds_read_b64_tr_b16 v[194:195], v8 offset:20736
    s_waitcnt lgkmcnt(6)
    v_mfma_f32_32x32x16_bf16 v[176:191], v[196:199], v[100:103], v[176:191]
    v_cmp_eq_u32 vcc, 26, v13
    v_cmp_eq_u32 s[58:59], 27, v13
    s_nop 0
    v_cndmask_b32 v167, 0, v168, vcc
    v_cndmask_b32 v167, v167, v169, s[58:59]
    ds_read_b64_tr_b16 v[196:197], v8 offset:21504
    ds_read_b64_tr_b16 v[198:199], v8 offset:21760
    s_waitcnt lgkmcnt(6)
    v_mfma_f32_32x32x16_bf16 v[176:191], v[200:203], v[104:107], v[176:191]
    ds_read_b64_tr_b16 v[200:201], v8 offset:22528
    ds_read_b64_tr_b16 v[202:203], v8 offset:22784
    s_waitcnt lgkmcnt(6)
    v_mfma_f32_32x32x16_bf16 v[176:191], v[204:207], v[108:111], v[176:191]
    ds_read_b64_tr_b16 v[204:205], v8 offset:23552
    ds_read_b64_tr_b16 v[206:207], v8 offset:23808
    s_waitcnt lgkmcnt(6)
    v_mfma_f32_32x32x16_bf16 v[176:191], v[192:195], v[112:115], v[176:191]
    v_and_b32 v14, 31, v1
    v_lshlrev_b32 v14, 2, v14
    v_add_u32 v244, 161280, v14
    ds_read2_b32 v[240:241], v244 offset0:0 offset1:32
    ds_read2_b32 v[242:243], v244 offset0:64 offset1:96
    s_lshl_b32 s56, s40, 8
    s_add_u32 s56, s56, 162560
    v_add_u32 v14, s56, v14
    v_lshrrev_b32 v15, 5, v1
    v_lshl_add_u32 v15, v15, 4, s56
    ds_read_b64_tr_b16 v[192:193], v8 offset:24576
    ds_read_b64_tr_b16 v[194:195], v8 offset:24832
    s_waitcnt lgkmcnt(8)
    v_mfma_f32_32x32x16_bf16 v[176:191], v[196:199], v[116:119], v[176:191]
    ds_read_b64_tr_b16 v[196:197], v8 offset:25600
    ds_read_b64_tr_b16 v[198:199], v8 offset:25856
    s_waitcnt lgkmcnt(8)
    v_mfma_f32_32x32x16_bf16 v[176:191], v[200:203], v[120:123], v[176:191]
    ds_read_b64_tr_b16 v[200:201], v8 offset:26624
    ds_read_b64_tr_b16 v[202:203], v8 offset:26880
    s_waitcnt lgkmcnt(8)
    v_mfma_f32_32x32x16_bf16 v[176:191], v[204:207], v[124:127], v[176:191]
    ds_read_b64_tr_b16 v[204:205], v8 offset:27648
    ds_read_b64_tr_b16 v[206:207], v8 offset:27904
    s_waitcnt lgkmcnt(6)
    v_mfma_f32_32x32x16_bf16 v[176:191], v[192:195], v[128:131], v[176:191]
    v_pk_add_f32 v[240:241], v[240:241], v[242:243]
    v_add_f32 v245, v240, v241
    ds_write_b32 v14, v245
    ds_read_b128 v[240:243], v15 offset:0
    ds_read_b128 v[244:247], v15 offset:32
    ds_read_b128 v[248:251], v15 offset:64
    ds_read_b128 v[252:255], v15 offset:96
    s_waitcnt lgkmcnt(9)
    v_mfma_f32_32x32x16_bf16 v[176:191], v[196:199], v[132:135], v[176:191]
    s_waitcnt lgkmcnt(7)
    v_mfma_f32_32x32x16_bf16 v[176:191], v[200:203], v[136:139], v[176:191]
    s_waitcnt lgkmcnt(5)
    v_mfma_f32_32x32x16_bf16 v[176:191], v[204:207], v[140:143], v[176:191]
    s_waitcnt vmcnt(0)
    v_mov_b32 v14, 1
    s_add_u32 s54, s3, s87
    s_add_u32 s53, s51, s54
    s_add_u32 s53, s53, 0x00018000
    s_mov_b64 exec, 1
    buffer_atomic_add v14, off, s[28:31], s53 sc1
    s_mov_b64 exec, -1
    s_lshl_b32 s94, s42, 2
    s_add_u32 s94, s94, s40
    s_lshl_b32 s94, s94, 13
    s_add_u32 s94, s94, s47
    s_add_u32 s94, s94, 0x00400000
    s_add_u32 s95, s94, 4096
    s_add_u32 s6, s51, s3
    s_add_u32 s6, s6, 98304
    s_mov_b32 s96, 0
    s_waitcnt lgkmcnt(0)
    v_pk_fma_f32 v[176:177], v[240:241], v[10:11], v[176:177] op_sel:[0,1,0] op_sel_hi:[1,1,1]
    v_pk_fma_f32 v[178:179], v[242:243], v[10:11], v[178:179] op_sel:[0,1,0] op_sel_hi:[1,1,1]
    v_pk_fma_f32 v[180:181], v[244:245], v[10:11], v[180:181] op_sel:[0,1,0] op_sel_hi:[1,1,1]
    v_pk_fma_f32 v[182:183], v[246:247], v[10:11], v[182:183] op_sel:[0,1,0] op_sel_hi:[1,1,1]
    v_pk_fma_f32 v[184:185], v[248:249], v[10:11], v[184:185] op_sel:[0,1,0] op_sel_hi:[1,1,1]
    v_pk_fma_f32 v[186:187], v[250:251], v[10:11], v[186:187] op_sel:[0,1,0] op_sel_hi:[1,1,1]
    v_pk_fma_f32 v[188:189], v[252:253], v[10:11], v[188:189] op_sel:[0,1,0] op_sel_hi:[1,1,1]
    v_pk_fma_f32 v[190:191], v[254:255], v[10:11], v[190:191] op_sel:[0,1,0] op_sel_hi:[1,1,1]
    v_pk_fma_f32 v[176:177], v[176:177], v[10:11], s[62:63] op_sel:[0,0,1] op_sel_hi:[1,0,1]
    v_pk_fma_f32 v[178:179], v[178:179], v[10:11], s[62:63] op_sel:[0,0,1] op_sel_hi:[1,0,1]
    v_pk_fma_f32 v[180:181], v[180:181], v[10:11], s[62:63] op_sel:[0,0,1] op_sel_hi:[1,0,1]
    v_pk_fma_f32 v[182:183], v[182:183], v[10:11], s[62:63] op_sel:[0,0,1] op_sel_hi:[1,0,1]
    v_pk_fma_f32 v[184:185], v[184:185], v[10:11], s[62:63] op_sel:[0,0,1] op_sel_hi:[1,0,1]
    v_pk_fma_f32 v[186:187], v[186:187], v[10:11], s[62:63] op_sel:[0,0,1] op_sel_hi:[1,0,1]
    v_pk_fma_f32 v[188:189], v[188:189], v[10:11], s[62:63] op_sel:[0,0,1] op_sel_hi:[1,0,1]
    v_pk_fma_f32 v[190:191], v[190:191], v[10:11], s[62:63] op_sel:[0,0,1] op_sel_hi:[1,0,1]
    s_cmp_lg_u32 s46, 0
    s_cbranch_scc1 L_A_nores
    v_permlane32_swap_b32 v24, v26
    v_permlane32_swap_b32 v25, v27
    v_permlane32_swap_b32 v28, v30
    v_permlane32_swap_b32 v29, v31
    v_lshlrev_b32 v16, 16, v24
    v_and_b32 v17, 0xffff0000, v24
    v_lshlrev_b32 v18, 16, v25
    v_and_b32 v19, 0xffff0000, v25
    v_lshlrev_b32 v20, 16, v26
    v_and_b32 v21, 0xffff0000, v26
    v_lshlrev_b32 v22, 16, v27
    v_and_b32 v23, 0xffff0000, v27
    v_lshlrev_b32 v24, 16, v28
    v_and_b32 v25, 0xffff0000, v28
    v_lshlrev_b32 v26, 16, v29
    v_and_b32 v27, 0xffff0000, v29
    v_lshlrev_b32 v28, 16, v30
    v_and_b32 v29, 0xffff0000, v30
    v_lshlrev_b32 v30, 16, v31
    v_and_b32 v31, 0xffff0000, v31
L_A_nores:
    s_barrier
L_A_mredo:
    buffer_load_dwordx4 v[32:35], v2, s[28:31], s94 offen offset:0 sc1
    buffer_load_dwordx4 v[36:39], v2, s[28:31], s94 offen offset:1024 sc1
    buffer_load_dwordx4 v[40:43], v2, s[28:31], s94 offen offset:2048 sc1
    buffer_load_dwordx4 v[44:47], v2, s[28:31], s94 offen offset:3072 sc1
    buffer_load_dwordx4 v[48:51], v2, s[28:31], s95 offen offset:0 sc1
    buffer_load_dwordx4 v[52:55], v2, s[28:31], s95 offen offset:1024 sc1
    buffer_load_dwordx4 v[56:59], v2, s[28:31], s95 offen offset:2048 sc1
    buffer_load_dwordx4 v[60:63], v2, s[28:31], s95 offen offset:3072 sc1
    s_cmp_lg_u32 s96, 0
    s_cbranch_scc1 L_A_nophi
    v_pk_mul_f32 v[240:241], v[176:177], s[62:63] op_sel:[0,0] op_sel_hi:[1,0]
    v_pk_mul_f32 v[242:243], v[178:179], s[62:63] op_sel:[0,0] op_sel_hi:[1,0]
    v_pk_mul_f32 v[244:245], v[180:181], s[62:63] op_sel:[0,0] op_sel_hi:[1,0]
    v_pk_mul_f32 v[246:247], v[182:183], s[62:63] op_sel:[0,0] op_sel_hi:[1,0]
    v_pk_mul_f32 v[248:249], v[184:185], s[62:63] op_sel:[0,0] op_sel_hi:[1,0]
    v_pk_mul_f32 v[250:251], v[186:187], s[62:63] op_sel:[0,0] op_sel_hi:[1,0]
    v_pk_mul_f32 v[252:253], v[188:189], s[62:63] op_sel:[0,0] op_sel_hi:[1,0]
    v_pk_mul_f32 v[254:255], v[190:191], s[62:63] op_sel:[0,0] op_sel_hi:[1,0]
    v_exp_f32_e64 v240, v240 clamp
    v_max_f32 v176, s63, v176
    v_exp_f32_e64 v241, v241 clamp
    v_max_f32 v177, s63, v177
    v_exp_f32_e64 v242, v242 clamp
    v_max_f32 v178, s63, v178
    v_exp_f32_e64 v243, v243 clamp
    v_max_f32 v179, s63, v179
    v_exp_f32_e64 v244, v244 clamp
    v_max_f32 v180, s63, v180
    v_exp_f32_e64 v245, v245 clamp
    v_max_f32 v181, s63, v181
    v_exp_f32_e64 v246, v246 clamp
    v_max_f32 v182, s63, v182
    v_exp_f32_e64 v247, v247 clamp
    v_max_f32 v183, s63, v183
    v_exp_f32_e64 v248, v248 clamp
    v_max_f32 v184, s63, v184
    v_exp_f32_e64 v249, v249 clamp
    v_max_f32 v185, s63, v185
    v_exp_f32_e64 v250, v250 clamp
    v_max_f32 v186, s63, v186
    v_exp_f32_e64 v251, v251 clamp
    v_max_f32 v187, s63, v187
    v_exp_f32_e64 v252, v252 clamp
    v_max_f32 v188, s63, v188
    v_exp_f32_e64 v253, v253 clamp
    v_max_f32 v189, s63, v189
    v_exp_f32_e64 v254, v254 clamp
    v_max_f32 v190, s63, v190
    v_exp_f32_e64 v255, v255 clamp
    v_max_f32 v191, s63, v191
    v_pk_add_f32 v[176:177], v[176:177], v[240:241]
    v_pk_add_f32 v[178:179], v[178:179], v[242:243]
    v_pk_add_f32 v[180:181], v[180:181], v[244:245]
    v_pk_add_f32 v[182:183], v[182:183], v[246:247]
    v_pk_add_f32 v[184:185], v[184:185], v[248:249]
    v_pk_add_f32 v[186:187], v[186:187], v[250:251]
    v_pk_add_f32 v[188:189], v[188:189], v[252:253]
    v_pk_add_f32 v[190:191], v[190:191], v[254:255]
    v_cvt_pk_bf16_f32 v192, v176, v177
    v_cvt_pk_bf16_f32 v193, v178, v179
    v_cvt_pk_bf16_f32 v194, v180, v181
    v_cvt_pk_bf16_f32 v195, v182, v183
    v_cvt_pk_bf16_f32 v196, v184, v185
    v_cvt_pk_bf16_f32 v197, v186, v187
    v_cvt_pk_bf16_f32 v198, v188, v189
    v_cvt_pk_bf16_f32 v199, v190, v191
    s_mov_b32 exec_lo, 0
    s_mov_b32 exec_hi, -1
    v_mov_b32 v198, 0
    v_mov_b32 v199, 0
    s_mov_b64 exec, -1
L_A_nophi:
    s_lshl_b32 s53, s40, 11
    s_add_u32 s53, s53, 144384
    v_add_u32 v12, s53, v2
    v_add_u32 v13, 144384, v2
    s_waitcnt vmcnt(7)
    v_mfma_f32_32x32x16_bf16 v[144:159], v[160:163], v[32:35], 0
    s_waitcnt vmcnt(6)
    v_mfma_f32_32x32x16_bf16 v[144:159], v[164:167], v[36:39], v[144:159]
    s_waitcnt vmcnt(5)
    v_mfma_f32_32x32x16_bf16 v[144:159], v[160:163], v[40:43], v[144:159]
    s_waitcnt vmcnt(4)
    v_mfma_f32_32x32x16_bf16 v[144:159], v[164:167], v[44:47], v[144:159]
    s_waitcnt vmcnt(3)
    v_mfma_f32_32x32x16_bf16 v[144:159], v[160:163], v[48:51], v[144:159]
    s_waitcnt vmcnt(2)
    v_mfma_f32_32x32x16_bf16 v[144:159], v[164:167], v[52:55], v[144:159]
    s_waitcnt vmcnt(1)
    v_mfma_f32_32x32x16_bf16 v[144:159], v[160:163], v[56:59], v[144:159]
    s_waitcnt vmcnt(0)
    v_mfma_f32_32x32x16_bf16 v[144:159], v[164:167], v[60:63], v[144:159]
    s_nop 11
    v_cvt_pk_bf16_f32 v96, v144, v145
    v_cvt_pk_bf16_f32 v97, v146, v147
    v_cvt_pk_bf16_f32 v98, v148, v149
    v_cvt_pk_bf16_f32 v99, v150, v151
    v_cvt_pk_bf16_f32 v100, v152, v153
    v_cvt_pk_bf16_f32 v101, v154, v155
    v_cvt_pk_bf16_f32 v102, v156, v157
    v_cvt_pk_bf16_f32 v103, v158, v159
    ds_write_b128 v12, v[96:99]
    ds_write_b128 v12, v[100:103] offset:1024
    v_cmp_u_f32 vcc, v144, v144
    s_nop 1
    s_cbranch_vccnz Lbad_121
Lok_122:
    s_waitcnt lgkmcnt(0)
    s_barrier
    ds_read_b128 v[32:35], v13 offset:0
    ds_read_b128 v[36:39], v13 offset:1024
    ds_read_b128 v[40:43], v13 offset:2048
    ds_read_b128 v[44:47], v13 offset:3072
    ds_read_b128 v[48:51], v13 offset:4096
    ds_read_b128 v[52:55], v13 offset:5120
    ds_read_b128 v[56:59], v13 offset:6144
    ds_read_b128 v[60:63], v13 offset:7168
    s_waitcnt lgkmcnt(7)
    v_mfma_f32_32x32x16_bf16 v[176:191], v[32:35], v[192:195], 0
    s_waitcnt lgkmcnt(6)
    v_mfma_f32_32x32x16_bf16 v[176:191], v[36:39], v[196:199], v[176:191]
    s_waitcnt lgkmcnt(5)
    v_mfma_f32_32x32x16_bf16 v[176:191], v[40:43], v[192:195], v[176:191]
    s_waitcnt lgkmcnt(4)
    v_mfma_f32_32x32x16_bf16 v[176:191], v[44:47], v[196:199], v[176:191]
    s_waitcnt lgkmcnt(3)
    v_mfma_f32_32x32x16_bf16 v[176:191], v[48:51], v[192:195], v[176:191]
    s_waitcnt lgkmcnt(2)
    v_mfma_f32_32x32x16_bf16 v[176:191], v[52:55], v[196:199], v[176:191]
    s_waitcnt lgkmcnt(1)
    v_mfma_f32_32x32x16_bf16 v[176:191], v[56:59], v[192:195], v[176:191]
    s_waitcnt lgkmcnt(0)
    v_mfma_f32_32x32x16_bf16 v[176:191], v[60:63], v[196:199], v[176:191]
    s_barrier
    s_nop 10
    v_mov_b32 v14, v188
    v_mov_b32 v15, v188
    s_lshl_b32 s54, s48, 4
    s_add_u32 s54, s54, s42
    v_permlane32_swap_b32 v14, v15
    v_add_f32 v15, 0x358637bd, v15
    v_rcp_f32 v14, v15
    s_lshl_b32 s54, s54, 11
    s_add_u32 s54, s54, s47
    s_add_u32 s54, s54, 0x00200000
    v_pk_mul_f32 v[176:177], v[176:177], v[14:15] op_sel:[0,0] op_sel_hi:[1,0]
    v_pk_mul_f32 v[178:179], v[178:179], v[14:15] op_sel:[0,0] op_sel_hi:[1,0]
    v_pk_mul_f32 v[180:181], v[180:181], v[14:15] op_sel:[0,0] op_sel_hi:[1,0]
    v_pk_mul_f32 v[182:183], v[182:183], v[14:15] op_sel:[0,0] op_sel_hi:[1,0]
    v_cvt_pk_bf16_f32 v144, v176, v177
    v_cvt_pk_bf16_f32 v145, v178, v179
    v_cvt_pk_bf16_f32 v146, v180, v181
    v_cvt_pk_bf16_f32 v147, v182, v183
    buffer_store_dwordx4 v[144:147], v2, s[28:31], s54 offen sc1
    v_pk_mul_f32 v[184:185], v[184:185], v[14:15] op_sel:[0,0] op_sel_hi:[1,0]
    v_pk_mul_f32 v[186:187], v[186:187], v[14:15] op_sel:[0,0] op_sel_hi:[1,0]
    v_pk_mul_f32 v[188:189], v[188:189], v[14:15] op_sel:[0,0] op_sel_hi:[1,0]
    v_pk_mul_f32 v[190:191], v[190:191], v[14:15] op_sel:[0,0] op_sel_hi:[1,0]
    v_mov_b32 v150, 0
    v_mov_b32 v151, 0
    v_cvt_pk_bf16_f32 v148, v184, v185
    v_cvt_pk_bf16_f32 v149, v186, v187
    s_mov_b32 exec_lo, -1
    s_mov_b32 exec_hi, 0
    v_cvt_pk_bf16_f32 v150, v188, v189
    v_cvt_pk_bf16_f32 v151, v190, v191
    s_mov_b64 exec, -1
    buffer_store_dwordx4 v[148:151], v2, s[28:31], s54 offen offset:1024 sc1
L_wo:
    s_cmp_eq_u32 s45, 0
    s_cbranch_scc1 L_wo_skip
    s_lshr_b32 s56, s40, 1
    s_lshl_b32 s53, s49, 1
    s_add_u32 s53, s53, s56
    s_lshl_b32 s95, s53, 14
    s_add_u32 s95, s95, s47
    s_add_u32 s95, s95, 0x00200000
    s_add_u32 s6, s51, s5
    s_add_u32 s6, s6, 106496
    s_mov_b32 s96, 0
    s_mul_i32 s82, s49, 28672
    s_cmp_eq_u32 s46, 3
    s_cbranch_scc1 L_wo_last
    s_lshl_b32 s54, s50, 11
    s_add_u32 s82, s82, s54
    s_add_u32 s82, s82, s47
    s_add_u32 s83, s82, 1024
    v_mov_b32 v12, v2
    s_branch L_wo_addr
L_wo_last:
    s_lshl_b32 s54, s50, 6
    s_add_u32 s82, s82, s54
    s_add_u32 s83, s82, 32
    v_mov_b32 v12, v7
    s_mov_b32 s32, s76
    s_mov_b32 s33, s77
    s_mov_b32 s34, 1835008
L_wo_addr:
    s_lshl_b32 s53, s40, 12
    s_add_u32 s54, s53, 144384
    v_add_u32 v10, s54, v2
    s_xor_b32 s53, s53, 8192
    s_add_u32 s53, s53, 144384
    v_add_u32 v11, s53, v2
    s_mul_i32 s85, s49, 14
    s_add_u32 s85, s85, s50
    s_lshl_b32 s85, s85, 8
    s_add_u32 s85, s85, s47
    s_add_u32 s85, s85, 0x00800000
    v_lshlrev_b32 v13, 3, v1
    s_barrier
L_wo_redo:
    s_mov_b32 s94, s95
    buffer_load_dwordx4 v[32:35], v2, s[28:31], s94 offen offset:0 sc1
    buffer_load_dwordx4 v[36:39], v2, s[28:31], s94 offen offset:1024 sc1
    buffer_load_dwordx4 v[40:43], v2, s[28:31], s94 offen offset:2048 sc1
    buffer_load_dwordx4 v[44:47], v2, s[28:31], s94 offen offset:3072 sc1
    s_add_u32 s94, s94, 4096
    buffer_load_dwordx4 v[48:51], v2, s[28:31], s94 offen offset:0 sc1
    buffer_load_dwordx4 v[52:55], v2, s[28:31], s94 offen offset:1024 sc1
    buffer_load_dwordx4 v[56:59], v2, s[28:31], s94 offen offset:2048 sc1
    buffer_load_dwordx4 v[60:63], v2, s[28:31], s94 offen offset:3072 sc1
    s_add_u32 s94, s94, 4096
    buffer_load_dwordx4 v[64:67], v2, s[28:31], s94 offen offset:0 sc1
    buffer_load_dwordx4 v[68:71], v2, s[28:31], s94 offen offset:1024 sc1
    buffer_load_dwordx4 v[72:75], v2, s[28:31], s94 offen offset:2048 sc1
    buffer_load_dwordx4 v[76:79], v2, s[28:31], s94 offen offset:3072 sc1
    s_add_u32 s94, s94, 4096
    buffer_load_dwordx4 v[80:83], v2, s[28:31], s94 offen offset:0 sc1
    buffer_load_dwordx4 v[84:87], v2, s[28:31], s94 offen offset:1024 sc1
    buffer_load_dwordx4 v[88:91], v2, s[28:31], s94 offen offset:2048 sc1
    buffer_load_dwordx4 v[92:95], v2, s[28:31], s94 offen offset:3072 sc1
    ds_read_b64_tr_b16 v[192:193], v5 offset:0
    ds_read_b64_tr_b16 v[194:195], v5 offset:1024
    ds_read_b64_tr_b16 v[196:197], v6 offset:0
    ds_read_b64_tr_b16 v[198:199], v6 offset:1024
    ds_read_b64_tr_b16 v[200:201], v5 offset:2048
    ds_read_b64_tr_b16 v[202:203], v5 offset:3072
    ds_read_b64_tr_b16 v[204:205], v6 offset:2048
    ds_read_b64_tr_b16 v[206:207], v6 offset:3072
    s_waitcnt vmcnt(15) lgkmcnt(4)
    v_mfma_f32_32x32x16_bf16 v[96:111], v[196:199], v[32:35], 0
    v_mfma_f32_32x32x16_bf16 v[144:159], v[192:195], v[32:35], v[16:31]
    ds_read_b64_tr_b16 v[192:193], v5 offset:3584
    ds_read_b64_tr_b16 v[194:195], v5 offset:4608
    ds_read_b64_tr_b16 v[196:197], v6 offset:3584
    ds_read_b64_tr_b16 v[198:199], v6 offset:4608
    s_waitcnt vmcnt(14) lgkmcnt(4)
    v_mfma_f32_32x32x16_bf16 v[96:111], v[204:207], v[36:39], v[96:111]
    v_mfma_f32_32x32x16_bf16 v[144:159], v[200:203], v[36:39], v[144:159]
    ds_read_b64_tr_b16 v[200:201], v5 offset:5632
    ds_read_b64_tr_b16 v[202:203], v5 offset:6656
    ds_read_b64_tr_b16 v[204:205], v6 offset:5632
    ds_read_b64_tr_b16 v[206:207], v6 offset:6656
    s_waitcnt vmcnt(13) lgkmcnt(4)
    v_mfma_f32_32x32x16_bf16 v[96:111], v[196:199], v[40:43], v[96:111]
    v_mfma_f32_32x32x16_bf16 v[144:159], v[192:195], v[40:43], v[144:159]
    ds_read_b64_tr_b16 v[192:193], v5 offset:7168
    ds_read_b64_tr_b16 v[194:195], v5 offset:8192
    ds_read_b64_tr_b16 v[196:197], v6 offset:7168
    ds_read_b64_tr_b16 v[198:199], v6 offset:8192
    s_waitcnt vmcnt(12) lgkmcnt(4)
    v_mfma_f32_32x32x16_bf16 v[96:111], v[204:207], v[44:47], v[96:111]
    v_mfma_f32_32x32x16_bf16 v[144:159], v[200:203], v[44:47], v[144:159]
    ds_read_b64_tr_b16 v[200:201], v5 offset:9216
    ds_read_b64_tr_b16 v[202:203], v5 offset:10240
    ds_read_b64_tr_b16 v[204:205], v6 offset:9216
    ds_read_b64_tr_b16 v[206:207], v6 offset:10240
    s_waitcnt vmcnt(11) lgkmcnt(4)
    v_mfma_f32_32x32x16_bf16 v[96:111], v[196:199], v[48:51], v[96:111]
    v_mfma_f32_32x32x16_bf16 v[144:159], v[192:195], v[48:51], v[144:159]
    ds_read_b64_tr_b16 v[192:193], v5 offset:10752
    ds_read_b64_tr_b16 v[194:195], v5 offset:11776
    ds_read_b64_tr_b16 v[196:197], v6 offset:10752
    ds_read_b64_tr_b16 v[198:199], v6 offset:11776
    s_waitcnt vmcnt(10) lgkmcnt(4)
    v_mfma_f32_32x32x16_bf16 v[96:111], v[204:207], v[52:55], v[96:111]
    v_mfma_f32_32x32x16_bf16 v[144:159], v[200:203], v[52:55], v[144:159]
    ds_read_b64_tr_b16 v[200:201], v5 offset:12800
    ds_read_b64_tr_b16 v[202:203], v5 offset:13824
    ds_read_b64_tr_b16 v[204:205], v6 offset:12800
    ds_read_b64_tr_b16 v[206:207], v6 offset:13824
    s_waitcnt vmcnt(9) lgkmcnt(4)
    v_mfma_f32_32x32x16_bf16 v[96:111], v[196:199], v[56:59], v[96:111]
    v_mfma_f32_32x32x16_bf16 v[144:159], v[192:195], v[56:59], v[144:159]
    ds_read_b64_tr_b16 v[192:193], v5 offset:14336
    ds_read_b64_tr_b16 v[194:195], v5 offset:15360
    ds_read_b64_tr_b16 v[196:197], v6 offset:14336
    ds_read_b64_tr_b16 v[198:199], v6 offset:15360
    s_waitcnt vmcnt(8) lgkmcnt(4)
    v_mfma_f32_32x32x16_bf16 v[96:111], v[204:207], v[60:63], v[96:111]
    v_mfma_f32_32x32x16_bf16 v[144:159], v[200:203], v[60:63], v[144:159]
    ds_read_b64_tr_b16 v[200:201], v5 offset:16384
    ds_read_b64_tr_b16 v[202:203], v5 offset:17408
    ds_read_b64_tr_b16 v[204:205], v6 offset:16384
    ds_read_b64_tr_b16 v[206:207], v6 offset:17408
    s_waitcnt vmcnt(7) lgkmcnt(4)
    v_mfma_f32_32x32x16_bf16 v[96:111], v[196:199], v[64:67], v[96:111]
    v_mfma_f32_32x32x16_bf16 v[144:159], v[192:195], v[64:67], v[144:159]
    ds_read_b64_tr_b16 v[192:193], v5 offset:17920
    ds_read_b64_tr_b16 v[194:195], v5 offset:18944
    ds_read_b64_tr_b16 v[196:197], v6 offset:17920
    ds_read_b64_tr_b16 v[198:199], v6 offset:18944
    s_waitcnt vmcnt(6) lgkmcnt(4)
    v_mfma_f32_32x32x16_bf16 v[96:111], v[204:207], v[68:71], v[96:111]
    v_mfma_f32_32x32x16_bf16 v[144:159], v[200:203], v[68:71], v[144:159]
    ds_read_b64_tr_b16 v[200:201], v5 offset:19968
    ds_read_b64_tr_b16 v[202:203], v5 offset:20992
    ds_read_b64_tr_b16 v[204:205], v6 offset:19968
    ds_read_b64_tr_b16 v[206:207], v6 offset:20992
    s_waitcnt vmcnt(5) lgkmcnt(4)
    v_mfma_f32_32x32x16_bf16 v[96:111], v[196:199], v[72:75], v[96:111]
    v_mfma_f32_32x32x16_bf16 v[144:159], v[192:195], v[72:75], v[144:159]
    ds_read_b64_tr_b16 v[192:193], v5 offset:21504
    ds_read_b64_tr_b16 v[194:195], v5 offset:22528
    ds_read_b64_tr_b16 v[196:197], v6 offset:21504
    ds_read_b64_tr_b16 v[198:199], v6 offset:22528
    s_waitcnt vmcnt(4) lgkmcnt(4)
    v_mfma_f32_32x32x16_bf16 v[96:111], v[204:207], v[76:79], v[96:111]
    v_mfma_f32_32x32x16_bf16 v[144:159], v[200:203], v[76:79], v[144:159]
    ds_read_b64_tr_b16 v[200:201], v5 offset:23552
    ds_read_b64_tr_b16 v[202:203], v5 offset:24576
    ds_read_b64_tr_b16 v[204:205], v6 offset:23552
    ds_read_b64_tr_b16 v[206:207], v6 offset:24576
    s_waitcnt vmcnt(3) lgkmcnt(4)
    v_mfma_f32_32x32x16_bf16 v[96:111], v[196:199], v[80:83], v[96:111]
    v_mfma_f32_32x32x16_bf16 v[144:159], v[192:195], v[80:83], v[144:159]
    ds_read_b64_tr_b16 v[192:193], v5 offset:25088
    ds_read_b64_tr_b16 v[194:195], v5 offset:26112
    ds_read_b64_tr_b16 v[196:197], v6 offset:25088
    ds_read_b64_tr_b16 v[198:199], v6 offset:26112
    s_waitcnt vmcnt(2) lgkmcnt(4)
    v_mfma_f32_32x32x16_bf16 v[96:111], v[204:207], v[84:87], v[96:111]
    v_mfma_f32_32x32x16_bf16 v[144:159], v[200:203], v[84:87], v[144:159]
    ds_read_b64_tr_b16 v[200:201], v5 offset:27136
    ds_read_b64_tr_b16 v[202:203], v5 offset:28160
    ds_read_b64_tr_b16 v[204:205], v6 offset:27136
    ds_read_b64_tr_b16 v[206:207], v6 offset:28160
    s_waitcnt vmcnt(1) lgkmcnt(4)
    v_mfma_f32_32x32x16_bf16 v[96:111], v[196:199], v[88:91], v[96:111]
    v_mfma_f32_32x32x16_bf16 v[144:159], v[192:195], v[88:91], v[144:159]
    s_waitcnt vmcnt(0) lgkmcnt(0)
    v_mfma_f32_32x32x16_bf16 v[96:111], v[204:207], v[92:95], v[96:111]
    v_mfma_f32_32x32x16_bf16 v[144:159], v[200:203], v[92:95], v[144:159]
    s_cmp_lg_u32 s96, 0
    s_cbranch_scc1 Ldl_123
    v_mov_b32 v14, 1
    s_add_u32 s54, s4, s87
    s_add_u32 s53, s51, s54
    s_add_u32 s53, s53, 0x0001a000
    s_mov_b64 exec, 1
    buffer_atomic_add v14, off, s[28:31], s53 sc1
    s_mov_b64 exec, -1
Ldl_123:
    s_nop 8
    ds_write_b128 v10, v[96:99] offset:0
    ds_write_b128 v10, v[100:103] offset:1024
    ds_write_b128 v10, v[104:107] offset:2048
    ds_write_b128 v10, v[108:111] offset:3072
    s_movk_i32 s53, 0x207
    v_cmp_class_f32_e64 vcc, v96, s53
    s_nop 1
    s_cbranch_vccnz Lbad_124
Lok_125:
    s_waitcnt lgkmcnt(0)
    s_barrier
    ds_read_b128 v[112:115], v11 offset:0
    ds_read_b128 v[116:119], v11 offset:1024
    ds_read_b128 v[120:123], v11 offset:2048
    ds_read_b128 v[124:127], v11 offset:3072
    s_waitcnt lgkmcnt(3)
    v_pk_add_f32 v[16:17], v[144:145], v[112:113]
    v_pk_add_f32 v[18:19], v[146:147], v[114:115]
    s_waitcnt lgkmcnt(2)
    v_pk_add_f32 v[20:21], v[148:149], v[116:117]
    v_pk_add_f32 v[22:23], v[150:151], v[118:119]
    s_waitcnt lgkmcnt(0)
    s_barrier
    v_cvt_pk_bf16_f32 v128, v16, v17
    v_cvt_pk_bf16_f32 v129, v18, v19
    v_cvt_pk_bf16_f32 v130, v20, v21
    v_cvt_pk_bf16_f32 v131, v22, v23
    s_nop 0
    v_permlane32_swap_b32 v128, v130
    v_permlane32_swap_b32 v129, v131
    s_cmp_eq_u32 s46, 3
    s_cbranch_scc1 Lfs_126
    buffer_store_dwordx4 v[128:131], v12, s[32:35], s82 offen sc1
    s_branch Lfe_127
Lfs_126:
    buffer_store_dwordx4 v[128:131], v12, s[32:35], s82 offen
Lfe_127:
    s_waitcnt lgkmcnt(1)
    v_pk_add_f32 v[24:25], v[152:153], v[120:121]
    v_pk_add_f32 v[26:27], v[154:155], v[122:123]
    s_waitcnt lgkmcnt(0)
    v_pk_add_f32 v[28:29], v[156:157], v[124:125]
    v_pk_add_f32 v[30:31], v[158:159], v[126:127]
    v_cvt_pk_bf16_f32 v132, v24, v25
    v_cvt_pk_bf16_f32 v133, v26, v27
    v_cvt_pk_bf16_f32 v134, v28, v29
    v_cvt_pk_bf16_f32 v135, v30, v31
    s_nop 0
    v_permlane32_swap_b32 v132, v134
    v_permlane32_swap_b32 v133, v135
    s_cmp_eq_u32 s46, 3
    s_cbranch_scc1 Lfs_128
    buffer_store_dwordx4 v[132:135], v12, s[32:35], s83 offen sc1
    s_branch Lfe_129
Lfs_128:
    buffer_store_dwordx4 v[132:135], v12, s[32:35], s83 offen
Lfe_129:
    s_cmp_eq_u32 s46, 3
    s_cbranch_scc1 L_fin
    v_pk_add_f32 v[112:113], v[16:17], v[18:19]
    v_pk_mul_f32 v[114:115], v[16:17], v[16:17]
    v_pk_fma_f32 v[114:115], v[18:19], v[18:19], v[114:115]
    v_pk_add_f32 v[112:113], v[112:113], v[20:21]
    v_pk_fma_f32 v[114:115], v[20:21], v[20:21], v[114:115]
    v_pk_add_f32 v[112:113], v[112:113], v[22:23]
    v_pk_fma_f32 v[114:115], v[22:23], v[22:23], v[114:115]
    v_pk_add_f32 v[112:113], v[112:113], v[24:25]
    v_pk_fma_f32 v[114:115], v[24:25], v[24:25], v[114:115]
    v_pk_add_f32 v[112:113], v[112:113], v[26:27]
    v_pk_fma_f32 v[114:115], v[26:27], v[26:27], v[114:115]
    v_pk_add_f32 v[112:113], v[112:113], v[28:29]
    v_pk_fma_f32 v[114:115], v[28:29], v[28:29], v[114:115]
    v_pk_add_f32 v[112:113], v[112:113], v[30:31]
    v_pk_fma_f32 v[114:115], v[30:31], v[30:31], v[114:115]
    v_add_f32 v116, v112, v113
    v_add_f32 v117, v114, v115
    v_add_f32 v118, v112, v113
    v_add_f32 v119, v114, v115
    s_nop 0
    v_permlane32_swap_b32 v116, v118
    v_permlane32_swap_b32 v117, v119
    v_pk_add_f32 v[116:117], v[116:117], v[118:119]
    s_mov_b32 exec_lo, -1
    s_mov_b32 exec_hi, 0
    buffer_store_dwordx2 v[116:117], v13, s[28:31], s85 offen sc1
    s_mov_b64 exec, -1
    s_branch L_next
L_wo_skip:
    s_waitcnt vmcnt(0)
    v_mov_b32 v14, 1
    s_add_u32 s54, s4, s87
    s_add_u32 s53, s51, s54
    s_add_u32 s53, s53, 0x0001a000
    s_mov_b64 exec, 1
    buffer_atomic_add v14, off, s[28:31], s53 sc1
    s_mov_b64 exec, -1
    s_barrier
    s_barrier
    s_cmp_eq_u32 s46, 3
    s_cbranch_scc1 L_fin
    s_barrier
L_next:
    s_add_u32 s46, s46, 1
    s_add_u32 s47, s47, 0x1000000
    s_add_u32 s51, s51, 24576
    s_bitcmp1_b32 s46, 0
    s_cbranch_scc0 L_A_later
L_layerB:
    s_add_u32 s6, s51, s4
    s_add_u32 s6, s6, 0x00016000
    s_mov_b32 s96, 0
    s_barrier
L_B_redo:
    s_mul_i32 s94, s48, 28672
    s_add_u32 s94, s94, s47
    s_sub_u32 s94, s94, 0x1000000
    buffer_load_dwordx4 v[32:35], v2, s[28:31], s94 offen offset:0 sc1
    buffer_load_dwordx4 v[36:39], v2, s[28:31], s94 offen offset:1024 sc1
    v_lshrrev_b32 v12, 5, v1
    v_mul_u32_u24 v12, 1792, v12
    v_and_b32 v13, 31, v1
    v_lshl_add_u32 v12, v13, 3, v12
    s_mul_i32 s54, s48, 3584
    s_add_u32 s54, s54, s47
    s_add_u32 s54, s54, 0xff800000
    buffer_load_dwordx2 v[176:177], v12, s[28:31], s54 offen offset:0 sc1
    buffer_load_dwordx2 v[178:179], v12, s[28:31], s54 offen offset:256 sc1
    buffer_load_dwordx2 v[180:181], v12, s[28:31], s54 offen offset:512 sc1
    buffer_load_dwordx2 v[182:183], v12, s[28:31], s54 offen offset:768 sc1
    buffer_load_dwordx2 v[184:185], v12, s[28:31], s54 offen offset:1024 sc1
    buffer_load_dwordx2 v[186:187], v12, s[28:31], s54 offen offset:1280 sc1
    buffer_load_dwordx2 v[188:189], v12, s[28:31], s54 offen offset:1536 sc1
    buffer_load_dwordx4 v[40:43], v2, s[28:31], s94 offen offset:2048 sc1
    buffer_load_dwordx4 v[44:47], v2, s[28:31], s94 offen offset:3072 sc1
    s_add_u32 s94, s94, 4096
    buffer_load_dwordx4 v[48:51], v2, s[28:31], s94 offen offset:0 sc1
    buffer_load_dwordx4 v[52:55], v2, s[28:31], s94 offen offset:1024 sc1
    buffer_load_dwordx4 v[56:59], v2, s[28:31], s94 offen offset:2048 sc1
    buffer_load_dwordx4 v[60:63], v2, s[28:31], s94 offen offset:3072 sc1
    s_add_u32 s94, s94, 4096
    buffer_load_dwordx4 v[64:67], v2, s[28:31], s94 offen offset:0 sc1
    buffer_load_dwordx4 v[68:71], v2, s[28:31], s94 offen offset:1024 sc1
    buffer_load_dwordx4 v[72:75], v2, s[28:31], s94 offen offset:2048 sc1
    buffer_load_dwordx4 v[76:79], v2, s[28:31], s94 offen offset:3072 sc1
    ds_read_b64_tr_b16 v[192:193], v3 offset:0
    ds_read_b64_tr_b16 v[194:195], v3 offset:512
    ds_read_b64_tr_b16 v[196:197], v4 offset:0
    ds_read_b64_tr_b16 v[198:199], v4 offset:512
    ds_read_b64_tr_b16 v[200:201], v3 offset:2048
    ds_read_b64_tr_b16 v[202:203], v3 offset:2560
    ds_read_b64_tr_b16 v[204:205], v4 offset:2048
    ds_read_b64_tr_b16 v[206:207], v4 offset:2560
    s_waitcnt vmcnt(18) lgkmcnt(4)
    v_mfma_f32_32x32x16_bf16 v[144:159], v[192:195], v[32:35], 0
    v_mfma_f32_32x32x16_bf16 v[160:175], v[32:35], v[196:199], 0
    s_add_u32 s94, s94, 4096
    buffer_load_dwordx4 v[80:83], v2, s[28:31], s94 offen offset:0 sc1
    ds_read_b64_tr_b16 v[192:193], v3 offset:4096
    ds_read_b64_tr_b16 v[194:195], v3 offset:4608
    ds_read_b64_tr_b16 v[196:197], v4 offset:4096
    ds_read_b64_tr_b16 v[198:199], v4 offset:4608
    s_waitcnt vmcnt(18) lgkmcnt(4)
    v_mfma_f32_32x32x16_bf16 v[144:159], v[200:203], v[36:39], v[144:159]
    v_mfma_f32_32x32x16_bf16 v[160:175], v[36:39], v[204:207], v[160:175]
    buffer_load_dwordx4 v[84:87], v2, s[28:31], s94 offen offset:1024 sc1
    ds_read_b64_tr_b16 v[200:201], v3 offset:6144
    ds_read_b64_tr_b16 v[202:203], v3 offset:6656
    ds_read_b64_tr_b16 v[204:205], v4 offset:6144
    ds_read_b64_tr_b16 v[206:207], v4 offset:6656
    s_waitcnt vmcnt(11) lgkmcnt(4)
    v_mfma_f32_32x32x16_bf16 v[144:159], v[192:195], v[40:43], v[144:159]
    v_mfma_f32_32x32x16_bf16 v[160:175], v[40:43], v[196:199], v[160:175]
    buffer_load_dwordx4 v[88:91], v2, s[28:31], s94 offen offset:2048 sc1
    v_pk_add_f32 v[176:177], v[176:177], v[178:179]
    v_pk_add_f32 v[176:177], v[176:177], v[180:181]
    v_pk_add_f32 v[176:177], v[176:177], v[182:183]
    v_pk_add_f32 v[176:177], v[176:177], v[184:185]
    v_pk_add_f32 v[176:177], v[176:177], v[186:187]
    v_pk_add_f32 v[176:177], v[176:177], v[188:189]
    ds_read_b64_tr_b16 v[192:193], v3 offset:8192
    ds_read_b64_tr_b16 v[194:195], v3 offset:8704
    ds_read_b64_tr_b16 v[196:197], v4 offset:8192
    ds_read_b64_tr_b16 v[198:199], v4 offset:8704
    s_waitcnt vmcnt(11) lgkmcnt(4)
    v_mfma_f32_32x32x16_bf16 v[144:159], v[200:203], v[44:47], v[144:159]
    v_mfma_f32_32x32x16_bf16 v[160:175], v[44:47], v[204:207], v[160:175]
    buffer_load_dwordx4 v[92:95], v2, s[28:31], s94 offen offset:3072 sc1
    v_mov_b32 v14, v176
    v_mov_b32 v15, v177
    s_nop 0
    v_permlane32_swap_b32 v14, v176
    v_permlane32_swap_b32 v15, v177
    v_add_f32 v176, v176, v14
    v_add_f32 v177, v177, v15
    v_mul_f32 v11, 0xbb124925, v176
    v_mul_f32 v177, 0x3b124925, v177
    v_fma_f32 v177, -v11, v11, v177
    v_and_b32 v177, 0x7fffffff, v177
    v_add_f32 v177, 0x3727c5ac, v177
    v_rsq_f32 v10, v177
    s_lshl_b32 s53, s40, 8
    s_add_u32 s53, s53, 162560
    v_and_b32 v14, 31, v1
    v_lshl_add_u32 v14, v14, 2, s53
    v_lshrrev_b32 v15, 5, v1
    v_lshl_add_u32 v15, v15, 4, s53
    ds_write_b32 v14, v10
    ds_write_b32 v14, v11 offset:128
    ds_read_b64_tr_b16 v[200:201], v3 offset:10240
    ds_read_b64_tr_b16 v[202:203], v3 offset:10752
    ds_read_b64_tr_b16 v[204:205], v4 offset:10240
    ds_read_b64_tr_b16 v[206:207], v4 offset:10752
    s_waitcnt vmcnt(11) lgkmcnt(6)
    v_mfma_f32_32x32x16_bf16 v[144:159], v[192:195], v[48:51], v[144:159]
    v_mfma_f32_32x32x16_bf16 v[160:175], v[48:51], v[196:199], v[160:175]
    s_add_u32 s94, s94, 4096
    buffer_load_dwordx4 v[96:99], v2, s[28:31], s94 offen offset:0 sc1
    ds_read_b64_tr_b16 v[192:193], v3 offset:12288
    ds_read_b64_tr_b16 v[194:195], v3 offset:12800
    ds_read_b64_tr_b16 v[196:197], v4 offset:12288
    ds_read_b64_tr_b16 v[198:199], v4 offset:12800
    s_waitcnt vmcnt(11) lgkmcnt(4)
    v_mfma_f32_32x32x16_bf16 v[144:159], v[200:203], v[52:55], v[144:159]
    v_mfma_f32_32x32x16_bf16 v[160:175], v[52:55], v[204:207], v[160:175]
    buffer_load_dwordx4 v[100:103], v2, s[28:31], s94 offen offset:1024 sc1
    ds_read_b128 v[208:211], v15 offset:0
    ds_read_b128 v[212:215], v15 offset:32
    ds_read_b128 v[216:219], v15 offset:64
    ds_read_b128 v[220:223], v15 offset:96
    ds_read_b64_tr_b16 v[200:201], v3 offset:14336
    ds_read_b64_tr_b16 v[202:203], v3 offset:14848
    ds_read_b64_tr_b16 v[204:205], v4 offset:14336
    ds_read_b64_tr_b16 v[206:207], v4 offset:14848
    s_waitcnt vmcnt(11) lgkmcnt(8)
    v_mfma_f32_32x32x16_bf16 v[144:159], v[192:195], v[56:59], v[144:159]
    v_mfma_f32_32x32x16_bf16 v[160:175], v[56:59], v[196:199], v[160:175]
    buffer_load_dwordx4 v[104:107], v2, s[28:31], s94 offen offset:2048 sc1
    ds_read_b64_tr_b16 v[192:193], v3 offset:16384
    ds_read_b64_tr_b16 v[194:195], v3 offset:16896
    ds_read_b64_tr_b16 v[196:197], v4 offset:16384
    ds_read_b64_tr_b16 v[198:199], v4 offset:16896
    s_waitcnt vmcnt(11) lgkmcnt(4)
    v_mfma_f32_32x32x16_bf16 v[144:159], v[200:203], v[60:63], v[144:159]
    v_mfma_f32_32x32x16_bf16 v[160:175], v[60:63], v[204:207], v[160:175]
    buffer_load_dwordx4 v[108:111], v2, s[28:31], s94 offen offset:3072 sc1
    ds_read_b128 v[224:227], v15 offset:128
    ds_read_b128 v[228:231], v15 offset:160
    ds_read_b128 v[232:235], v15 offset:192
    ds_read_b128 v[236:239], v15 offset:224
    ds_read_b64_tr_b16 v[200:201], v3 offset:18432
    ds_read_b64_tr_b16 v[202:203], v3 offset:18944
    ds_read_b64_tr_b16 v[204:205], v4 offset:18432
    ds_read_b64_tr_b16 v[206:207], v4 offset:18944
    s_waitcnt vmcnt(11) lgkmcnt(8)
    v_mfma_f32_32x32x16_bf16 v[144:159], v[192:195], v[64:67], v[144:159]
    v_mfma_f32_32x32x16_bf16 v[160:175], v[64:67], v[196:199], v[160:175]
    s_add_u32 s94, s94, 4096
    buffer_load_dwordx4 v[112:115], v2, s[28:31], s94 offen offset:0 sc1
    ds_read_b64_tr_b16 v[192:193], v3 offset:20480
    ds_read_b64_tr_b16 v[194:195], v3 offset:20992
    ds_read_b64_tr_b16 v[196:197], v4 offset:20480
    ds_read_b64_tr_b16 v[198:199], v4 offset:20992
    s_waitcnt vmcnt(11) lgkmcnt(4)
    v_mfma_f32_32x32x16_bf16 v[144:159], v[200:203], v[68:71], v[144:159]
    v_mfma_f32_32x32x16_bf16 v[160:175], v[68:71], v[204:207], v[160:175]
    buffer_load_dwordx4 v[116:119], v2, s[28:31], s94 offen offset:1024 sc1
    v_and_b32 v14, 31, v1
    v_lshlrev_b32 v14, 2, v14
    v_add_u32 v14, 161792, v14
    ds_read2_b32 v[178:179], v14 offset0:64 offset1:160
    ds_read_b64_tr_b16 v[200:201], v3 offset:22528
    ds_read_b64_tr_b16 v[202:203], v3 offset:23040
    ds_read_b64_tr_b16 v[204:205], v4 offset:22528
    ds_read_b64_tr_b16 v[206:207], v4 offset:23040
    s_waitcnt vmcnt(11) lgkmcnt(5)
    v_mfma_f32_32x32x16_bf16 v[144:159], v[192:195], v[72:75], v[144:159]
    v_mfma_f32_32x32x16_bf16 v[160:175], v[72:75], v[196:199], v[160:175]
    buffer_load_dwordx4 v[120:123], v2, s[28:31], s94 offen offset:2048 sc1
    ds_read_b64_tr_b16 v[192:193], v3 offset:24576
    ds_read_b64_tr_b16 v[194:195], v3 offset:25088
    ds_read_b64_tr_b16 v[196:197], v4 offset:24576
    ds_read_b64_tr_b16 v[198:199], v4 offset:25088
    s_waitcnt vmcnt(11) lgkmcnt(4)
    v_mfma_f32_32x32x16_bf16 v[144:159], v[200:203], v[76:79], v[144:159]
    v_mfma_f32_32x32x16_bf16 v[160:175], v[76:79], v[204:207], v[160:175]
    buffer_load_dwordx4 v[124:127], v2, s[28:31], s94 offen offset:3072 sc1
    v_add_f32 v13, v178, v179
    ds_read_b64_tr_b16 v[200:201], v3 offset:26624
    ds_read_b64_tr_b16 v[202:203], v3 offset:27136
    ds_read_b64_tr_b16 v[204:205], v4 offset:26624
    ds_read_b64_tr_b16 v[206:207], v4 offset:27136
    s_waitcnt vmcnt(11) lgkmcnt(4)
    v_mfma_f32_32x32x16_bf16 v[144:159], v[192:195], v[80:83], v[144:159]
    v_mfma_f32_32x32x16_bf16 v[160:175], v[80:83], v[196:199], v[160:175]
    s_add_u32 s94, s94, 4096
    buffer_load_dwordx4 v[128:131], v2, s[28:31], s94 offen offset:0 sc1
    v_and_b32 v14, 31, v1
    v_lshlrev_b32 v14, 2, v14
    v_add_u32 v244, 161920, v14
    ds_read2_b32 v[240:241], v244 offset0:0 offset1:96
    s_lshl_b32 s56, s40, 8
    s_add_u32 s56, s56, 162560
    v_add_u32 v14, s56, v14
    v_lshrrev_b32 v15, 5, v1
    v_lshl_add_u32 v15, v15, 4, s56
    ds_read_b64_tr_b16 v[192:193], v3 offset:28672
    ds_read_b64_tr_b16 v[194:195], v3 offset:29184
    ds_read_b64_tr_b16 v[196:197], v4 offset:28672
    ds_read_b64_tr_b16 v[198:199], v4 offset:29184
    s_waitcnt vmcnt(11) lgkmcnt(5)
    v_mfma_f32_32x32x16_bf16 v[144:159], v[200:203], v[84:87], v[144:159]
    v_mfma_f32_32x32x16_bf16 v[160:175], v[84:87], v[204:207], v[160:175]
    buffer_load_dwordx4 v[132:135], v2, s[28:31], s94 offen offset:1024 sc1
    ds_read_b64_tr_b16 v[200:201], v3 offset:30720
    ds_read_b64_tr_b16 v[202:203], v3 offset:31232
    ds_read_b64_tr_b16 v[204:205], v4 offset:30720
    ds_read_b64_tr_b16 v[206:207], v4 offset:31232
    s_waitcnt vmcnt(11) lgkmcnt(4)
    v_mfma_f32_32x32x16_bf16 v[144:159], v[192:195], v[88:91], v[144:159]
    v_mfma_f32_32x32x16_bf16 v[160:175], v[88:91], v[196:199], v[160:175]
    buffer_load_dwordx4 v[136:139], v2, s[28:31], s94 offen offset:2048 sc1
    v_and_b32 v12, 0xffff0000, v9
    ds_read_b64_tr_b16 v[192:193], v3 offset:32768
    ds_read_b64_tr_b16 v[194:195], v3 offset:33280
    ds_read_b64_tr_b16 v[196:197], v4 offset:32768
    ds_read_b64_tr_b16 v[198:199], v4 offset:33280
    s_waitcnt vmcnt(11) lgkmcnt(4)
    v_mfma_f32_32x32x16_bf16 v[144:159], v[200:203], v[92:95], v[144:159]
    v_mfma_f32_32x32x16_bf16 v[160:175], v[92:95], v[204:207], v[160:175]
    buffer_load_dwordx4 v[140:143], v2, s[28:31], s94 offen offset:3072 sc1
    v_add_f32 v245, v240, v241
    ds_write_b32 v14, v245
    ds_read_b128 v[240:243], v15 offset:0
    ds_read_b128 v[244:247], v15 offset:32
    ds_read_b128 v[248:251], v15 offset:64
    ds_read_b128 v[252:255], v15 offset:96
    ds_read_b64_tr_b16 v[200:201], v3 offset:34816
    ds_read_b64_tr_b16 v[202:203], v3 offset:35328
    ds_read_b64_tr_b16 v[204:205], v4 offset:34816
    ds_read_b64_tr_b16 v[206:207], v4 offset:35328
    s_waitcnt vmcnt(11) lgkmcnt(9)
    v_mfma_f32_32x32x16_bf16 v[144:159], v[192:195], v[96:99], v[144:159]
    v_mfma_f32_32x32x16_bf16 v[160:175], v[96:99], v[196:199], v[160:175]
    ds_read_b64_tr_b16 v[192:193], v3 offset:36864
    ds_read_b64_tr_b16 v[194:195], v3 offset:37376
    ds_read_b64_tr_b16 v[196:197], v4 offset:36864
    ds_read_b64_tr_b16 v[198:199], v4 offset:37376
    s_waitcnt vmcnt(10) lgkmcnt(4)
    v_mfma_f32_32x32x16_bf16 v[144:159], v[200:203], v[100:103], v[144:159]
    v_mfma_f32_32x32x16_bf16 v[160:175], v[100:103], v[204:207], v[160:175]
    ds_read_b64_tr_b16 v[200:201], v3 offset:38912
    ds_read_b64_tr_b16 v[202:203], v3 offset:39424
    ds_read_b64_tr_b16 v[204:205], v4 offset:38912
    ds_read_b64_tr_b16 v[206:207], v4 offset:39424
    s_waitcnt vmcnt(9) lgkmcnt(4)
    v_mfma_f32_32x32x16_bf16 v[144:159], v[192:195], v[104:107], v[144:159]
    v_mfma_f32_32x32x16_bf16 v[160:175], v[104:107], v[196:199], v[160:175]
    ds_read_b64_tr_b16 v[192:193], v3 offset:40960
    ds_read_b64_tr_b16 v[194:195], v3 offset:41472
    ds_read_b64_tr_b16 v[196:197], v4 offset:40960
    ds_read_b64_tr_b16 v[198:199], v4 offset:41472
    s_waitcnt vmcnt(8) lgkmcnt(4)
    v_mfma_f32_32x32x16_bf16 v[144:159], v[200:203], v[108:111], v[144:159]
    v_mfma_f32_32x32x16_bf16 v[160:175], v[108:111], v[204:207], v[160:175]
    ds_read_b64_tr_b16 v[200:201], v3 offset:43008
    ds_read_b64_tr_b16 v[202:203], v3 offset:43520
    ds_read_b64_tr_b16 v[204:205], v4 offset:43008
    ds_read_b64_tr_b16 v[206:207], v4 offset:43520
    s_waitcnt vmcnt(7) lgkmcnt(4)
    v_mfma_f32_32x32x16_bf16 v[144:159], v[192:195], v[112:115], v[144:159]
    v_mfma_f32_32x32x16_bf16 v[160:175], v[112:115], v[196:199], v[160:175]
    ds_read_b64_tr_b16 v[192:193], v3 offset:45056
    ds_read_b64_tr_b16 v[194:195], v3 offset:45568
    ds_read_b64_tr_b16 v[196:197], v4 offset:45056
    ds_read_b64_tr_b16 v[198:199], v4 offset:45568
    s_waitcnt vmcnt(6) lgkmcnt(4)
    v_mfma_f32_32x32x16_bf16 v[144:159], v[200:203], v[116:119], v[144:159]
    v_mfma_f32_32x32x16_bf16 v[160:175], v[116:119], v[204:207], v[160:175]
    ds_read_b64_tr_b16 v[200:201], v3 offset:47104
    ds_read_b64_tr_b16 v[202:203], v3 offset:47616
    ds_read_b64_tr_b16 v[204:205], v4 offset:47104
    ds_read_b64_tr_b16 v[206:207], v4 offset:47616
    s_waitcnt vmcnt(5) lgkmcnt(4)
    v_mfma_f32_32x32x16_bf16 v[144:159], v[192:195], v[120:123], v[144:159]
    v_mfma_f32_32x32x16_bf16 v[160:175], v[120:123], v[196:199], v[160:175]
    ds_read_b64_tr_b16 v[192:193], v3 offset:49152
    ds_read_b64_tr_b16 v[194:195], v3 offset:49664
    ds_read_b64_tr_b16 v[196:197], v4 offset:49152
    ds_read_b64_tr_b16 v[198:199], v4 offset:49664
    s_waitcnt vmcnt(4) lgkmcnt(4)
    v_mfma_f32_32x32x16_bf16 v[144:159], v[200:203], v[124:127], v[144:159]
    v_mfma_f32_32x32x16_bf16 v[160:175], v[124:127], v[204:207], v[160:175]
    ds_read_b64_tr_b16 v[200:201], v3 offset:51200
    ds_read_b64_tr_b16 v[202:203], v3 offset:51712
    ds_read_b64_tr_b16 v[204:205], v4 offset:51200
    ds_read_b64_tr_b16 v[206:207], v4 offset:51712
    s_waitcnt vmcnt(3) lgkmcnt(4)
    v_mfma_f32_32x32x16_bf16 v[144:159], v[192:195], v[128:131], v[144:159]
    v_mfma_f32_32x32x16_bf16 v[160:175], v[128:131], v[196:199], v[160:175]
    ds_read_b64_tr_b16 v[192:193], v3 offset:53248
    ds_read_b64_tr_b16 v[194:195], v3 offset:53760
    ds_read_b64_tr_b16 v[196:197], v4 offset:53248
    ds_read_b64_tr_b16 v[198:199], v4 offset:53760
    s_waitcnt vmcnt(2) lgkmcnt(4)
    v_mfma_f32_32x32x16_bf16 v[144:159], v[200:203], v[132:135], v[144:159]
    v_mfma_f32_32x32x16_bf16 v[160:175], v[132:135], v[204:207], v[160:175]
    ds_read_b64_tr_b16 v[200:201], v3 offset:55296
    ds_read_b64_tr_b16 v[202:203], v3 offset:55808
    ds_read_b64_tr_b16 v[204:205], v4 offset:55296
    ds_read_b64_tr_b16 v[206:207], v4 offset:55808
    s_waitcnt vmcnt(1) lgkmcnt(4)
    v_mfma_f32_32x32x16_bf16 v[144:159], v[192:195], v[136:139], v[144:159]
    v_mfma_f32_32x32x16_bf16 v[160:175], v[136:139], v[196:199], v[160:175]
    s_waitcnt vmcnt(0) lgkmcnt(0)
    v_mfma_f32_32x32x16_bf16 v[144:159], v[200:203], v[140:143], v[144:159]
    v_mfma_f32_32x32x16_bf16 v[160:175], v[140:143], v[204:207], v[160:175]
    s_cmp_lg_u32 s96, 0
    s_cbranch_scc1 Ldl_130
    s_cmp_eq_u32 s45, 0
    s_cbranch_scc1 Ldl_130
    v_mov_b32 v14, 1
    s_add_u32 s54, s5, s87
    s_add_u32 s53, s51, s54
    s_add_u32 s53, s53, 0x00016000
    s_mov_b64 exec, 1
    buffer_atomic_add v14, off, s[28:31], s53 sc1
    s_mov_b64 exec, -1
Ldl_130:
    s_lshl_b32 s55, s42, 6
    s_add_u32 s55, s55, s48
    s_lshl_b32 s55, s55, 12
    s_add_u32 s55, s55, s47
    s_add_u32 s55, s55, 0x00400000
    s_nop 3
    v_pk_fma_f32 v[144:145], v[240:241], v[10:11], v[144:145] op_sel:[0,1,0] op_sel_hi:[1,1,1]
    v_pk_fma_f32 v[146:147], v[242:243], v[10:11], v[146:147] op_sel:[0,1,0] op_sel_hi:[1,1,1]
    v_pk_fma_f32 v[148:149], v[244:245], v[10:11], v[148:149] op_sel:[0,1,0] op_sel_hi:[1,1,1]
    v_pk_fma_f32 v[150:151], v[246:247], v[10:11], v[150:151] op_sel:[0,1,0] op_sel_hi:[1,1,1]
    v_pk_fma_f32 v[152:153], v[248:249], v[10:11], v[152:153] op_sel:[0,1,0] op_sel_hi:[1,1,1]
    v_pk_fma_f32 v[154:155], v[250:251], v[10:11], v[154:155] op_sel:[0,1,0] op_sel_hi:[1,1,1]
    v_pk_fma_f32 v[156:157], v[252:253], v[10:11], v[156:157] op_sel:[0,1,0] op_sel_hi:[1,1,1]
    v_pk_fma_f32 v[158:159], v[254:255], v[10:11], v[158:159] op_sel:[0,1,0] op_sel_hi:[1,1,1]
    v_pk_mul_f32 v[144:145], v[144:145], v[10:11] op_sel:[0,0] op_sel_hi:[1,0]
    v_pk_mul_f32 v[146:147], v[146:147], v[10:11] op_sel:[0,0] op_sel_hi:[1,0]
    v_pk_mul_f32 v[148:149], v[148:149], v[10:11] op_sel:[0,0] op_sel_hi:[1,0]
    v_pk_mul_f32 v[150:151], v[150:151], v[10:11] op_sel:[0,0] op_sel_hi:[1,0]
    v_pk_mul_f32 v[152:153], v[152:153], v[10:11] op_sel:[0,0] op_sel_hi:[1,0]
    v_pk_mul_f32 v[154:155], v[154:155], v[10:11] op_sel:[0,0] op_sel_hi:[1,0]
    v_pk_mul_f32 v[156:157], v[156:157], v[10:11] op_sel:[0,0] op_sel_hi:[1,0]
    v_pk_mul_f32 v[158:159], v[158:159], v[10:11] op_sel:[0,0] op_sel_hi:[1,0]
    v_cmp_u_f32 vcc, v144, v144
    s_nop 1
    s_cbranch_vccnz Lbad_131
Lok_132:
    v_cvt_pk_bf16_f32 v240, v144, v145
    v_cvt_pk_bf16_f32 v241, v146, v147
    v_cvt_pk_bf16_f32 v242, v148, v149
    v_cvt_pk_bf16_f32 v243, v150, v151
    v_cvt_pk_bf16_f32 v244, v152, v153
    v_cvt_pk_bf16_f32 v245, v154, v155
    v_cvt_pk_bf16_f32 v246, v156, v157
    v_cvt_pk_bf16_f32 v247, v158, v159
    s_mov_b32 exec_lo, 0
    s_mov_b32 exec_hi, -1
    v_mov_b32 v246, 0x3f803f80
    v_mov_b32 v247, 0x3f80
    s_mov_b64 exec, -1
    buffer_store_dwordx4 v[240:243], v2, s[28:31], s55 offen offset:0 sc1
    buffer_store_dwordx4 v[244:247], v2, s[28:31], s55 offen offset:1024 sc1
    v_pk_fma_f32 v[160:161], v[224:225], v[12:13], v[160:161] op_sel:[0,1,0] op_sel_hi:[1,1,1]
    v_pk_fma_f32 v[162:163], v[226:227], v[12:13], v[162:163] op_sel:[0,1,0] op_sel_hi:[1,1,1]
    v_pk_fma_f32 v[164:165], v[228:229], v[12:13], v[164:165] op_sel:[0,1,0] op_sel_hi:[1,1,1]
    v_pk_fma_f32 v[166:167], v[230:231], v[12:13], v[166:167] op_sel:[0,1,0] op_sel_hi:[1,1,1]
    v_pk_fma_f32 v[168:169], v[232:233], v[12:13], v[168:169] op_sel:[0,1,0] op_sel_hi:[1,1,1]
    v_pk_fma_f32 v[170:171], v[234:235], v[12:13], v[170:171] op_sel:[0,1,0] op_sel_hi:[1,1,1]
    v_pk_fma_f32 v[172:173], v[236:237], v[12:13], v[172:173] op_sel:[0,1,0] op_sel_hi:[1,1,1]
    v_pk_fma_f32 v[174:175], v[238:239], v[12:13], v[174:175] op_sel:[0,1,0] op_sel_hi:[1,1,1]
    v_pk_fma_f32 v[160:161], v[160:161], v[208:209], v[12:13] op_sel:[0,0,0] op_sel_hi:[1,1,0]
    v_pk_fma_f32 v[162:163], v[162:163], v[210:211], v[12:13] op_sel:[0,0,0] op_sel_hi:[1,1,0]
    v_pk_fma_f32 v[164:165], v[164:165], v[212:213], v[12:13] op_sel:[0,0,0] op_sel_hi:[1,1,0]
    v_pk_fma_f32 v[166:167], v[166:167], v[214:215], v[12:13] op_sel:[0,0,0] op_sel_hi:[1,1,0]
    v_pk_fma_f32 v[168:169], v[168:169], v[216:217], v[12:13] op_sel:[0,0,0] op_sel_hi:[1,1,0]
    v_pk_fma_f32 v[170:171], v[170:171], v[218:219], v[12:13] op_sel:[0,0,0] op_sel_hi:[1,1,0]
    v_pk_fma_f32 v[172:173], v[172:173], v[220:221], v[12:13] op_sel:[0,0,0] op_sel_hi:[1,1,0]
    v_pk_fma_f32 v[174:175], v[174:175], v[222:223], v[12:13] op_sel:[0,0,0] op_sel_hi:[1,1,0]
    v_cvt_pk_bf16_f32 v248, v160, v161
    v_cvt_pk_bf16_f32 v249, v162, v163
    v_cvt_pk_bf16_f32 v250, v164, v165
    v_cvt_pk_bf16_f32 v251, v166, v167
    v_cvt_pk_bf16_f32 v252, v168, v169
    v_cvt_pk_bf16_f32 v253, v170, v171
    v_cvt_pk_bf16_f32 v254, v172, v173
    v_cvt_pk_bf16_f32 v255, v174, v175
    buffer_store_dwordx4 v[248:251], v2, s[28:31], s55 offen offset:2048 sc1
    buffer_store_dwordx4 v[252:255], v2, s[28:31], s55 offen offset:3072 sc1
    v_pk_mul_f32 v[12:13], v[144:145], v[144:145]
    v_pk_fma_f32 v[12:13], v[146:147], v[146:147], v[12:13]
    v_pk_fma_f32 v[12:13], v[148:149], v[148:149], v[12:13]
    v_pk_fma_f32 v[12:13], v[150:151], v[150:151], v[12:13]
    v_pk_fma_f32 v[12:13], v[152:153], v[152:153], v[12:13]
    v_pk_fma_f32 v[12:13], v[154:155], v[154:155], v[12:13]
    v_pk_fma_f32 v[12:13], v[156:157], v[156:157], v[12:13]
    v_pk_fma_f32 v[12:13], v[158:159], v[158:159], v[12:13]
    v_add_f32 v14, v12, v13
    v_add_f32 v15, v12, v13
    s_nop 1
    v_permlane32_swap_b32 v14, v15
    v_add_f32 v14, v14, v15
    s_nop 1
    v_max_f32_dpp v14, v14, v14 row_ror:1 row_mask:0xf bank_mask:0xf
    s_nop 1
    v_max_f32_dpp v14, v14, v14 row_ror:2 row_mask:0xf bank_mask:0xf
    s_nop 1
    v_max_f32_dpp v14, v14, v14 row_ror:4 row_mask:0xf bank_mask:0xf
    s_nop 1
    v_max_f32_dpp v14, v14, v14 row_ror:8 row_mask:0xf bank_mask:0xf
    s_nop 0
    v_readlane_b32 s55, v14, 16
    s_add_u32 s53, s51, s3
    s_add_u32 s53, s53, s87
    s_lshl_b32 s54, s41, 2
    s_add_u32 s53, s53, s54
    v_max3_u32 v12, s55, v14, 1
    s_mov_b64 exec, 1
    buffer_atomic_add v12, off, s[28:31], s53 sc1
    s_mov_b64 exec, -1
    s_cmp_lg_u32 s46, 1
    s_cbranch_scc1 L_B_cs
    s_barrier
L_B_cs:
    ds_read_b64_tr_b16 v[192:193], v8 offset:0
    ds_read_b64_tr_b16 v[194:195], v8 offset:256
    ds_read_b64_tr_b16 v[196:197], v8 offset:1024
    ds_read_b64_tr_b16 v[198:199], v8 offset:1280
    ds_read_b64_tr_b16 v[200:201], v8 offset:2048
    ds_read_b64_tr_b16 v[202:203], v8 offset:2304
    ds_read_b64_tr_b16 v[204:205], v8 offset:3072
    ds_read_b64_tr_b16 v[206:207], v8 offset:3328
    s_waitcnt lgkmcnt(6)
    v_mfma_f32_32x32x16_bf16 v[176:191], v[192:195], v[32:35], 0
    ds_read_b64_tr_b16 v[192:193], v8 offset:4096
    ds_read_b64_tr_b16 v[194:195], v8 offset:4352
    s_waitcnt lgkmcnt(6)
    v_mfma_f32_32x32x16_bf16 v[176:191], v[196:199], v[36:39], v[176:191]
    ds_read_b64_tr_b16 v[196:197], v8 offset:5120
    ds_read_b64_tr_b16 v[198:199], v8 offset:5376
    s_waitcnt lgkmcnt(6)
    v_mfma_f32_32x32x16_bf16 v[176:191], v[200:203], v[40:43], v[176:191]
    v_and_b32 v14, 31, v1
    v_lshlrev_b32 v14, 2, v14
    v_add_u32 v228, 161792, v14
    ds_read2_b32 v[224:225], v228 offset0:0 offset1:96
    s_lshl_b32 s56, s40, 8
    s_add_u32 s56, s56, 162560
    v_add_u32 v14, s56, v14
    v_lshrrev_b32 v15, 5, v1
    v_lshl_add_u32 v15, v15, 4, s56
    ds_read_b64_tr_b16 v[200:201], v8 offset:6144
    ds_read_b64_tr_b16 v[202:203], v8 offset:6400
    s_waitcnt lgkmcnt(7)
    v_mfma_f32_32x32x16_bf16 v[176:191], v[204:207], v[44:47], v[176:191]
    ds_read_b64_tr_b16 v[204:205], v8 offset:7168
    ds_read_b64_tr_b16 v[206:207], v8 offset:7424
    s_waitcnt lgkmcnt(7)
    v_mfma_f32_32x32x16_bf16 v[176:191], v[192:195], v[48:51], v[176:191]
    ds_read_b64_tr_b16 v[192:193], v8 offset:8192
    ds_read_b64_tr_b16 v[194:195], v8 offset:8448
    s_waitcnt lgkmcnt(7)
    v_mfma_f32_32x32x16_bf16 v[176:191], v[196:199], v[52:55], v[176:191]
    ds_read_b64_tr_b16 v[196:197], v8 offset:9216
    ds_read_b64_tr_b16 v[198:199], v8 offset:9472
    s_waitcnt lgkmcnt(6)
    v_mfma_f32_32x32x16_bf16 v[176:191], v[200:203], v[56:59], v[176:191]
    v_add_f32 v229, v224, v225
    ds_write_b32 v14, v229
    ds_read_b128 v[224:227], v15 offset:0
    ds_read_b128 v[228:231], v15 offset:32
    ds_read_b128 v[232:235], v15 offset:64
    ds_read_b128 v[236:239], v15 offset:96
    ds_read_b64_tr_b16 v[200:201], v8 offset:10240
    ds_read_b64_tr_b16 v[202:203], v8 offset:10496
    s_waitcnt lgkmcnt(11)
    v_mfma_f32_32x32x16_bf16 v[176:191], v[204:207], v[60:63], v[176:191]
    ds_read_b64_tr_b16 v[204:205], v8 offset:11264
    ds_read_b64_tr_b16 v[206:207], v8 offset:11520
    s_waitcnt lgkmcnt(11)
    v_mfma_f32_32x32x16_bf16 v[176:191], v[192:195], v[64:67], v[176:191]
    ds_read_b64_tr_b16 v[192:193], v8 offset:12288
    ds_read_b64_tr_b16 v[194:195], v8 offset:12544
    s_waitcnt lgkmcnt(11)
    v_mfma_f32_32x32x16_bf16 v[176:191], v[196:199], v[68:71], v[176:191]
    v_mov_b32 v64, 0
    v_mov_b32 v65, 0
    v_mov_b32 v66, 0
    v_mov_b32 v67, 0
    ds_read_b64_tr_b16 v[196:197], v8 offset:13312
    ds_read_b64_tr_b16 v[198:199], v8 offset:13568
    s_waitcnt lgkmcnt(6)
    v_mfma_f32_32x32x16_bf16 v[176:191], v[200:203], v[72:75], v[176:191]
    v_mov_b32 v68, 0
    v_mov_b32 v69, 0
    v_mov_b32 v70, 0
    v_mov_b32 v71, 0
    ds_read_b64_tr_b16 v[200:201], v8 offset:14336
    ds_read_b64_tr_b16 v[202:203], v8 offset:14592
    s_waitcnt lgkmcnt(6)
    v_mfma_f32_32x32x16_bf16 v[176:191], v[204:207], v[76:79], v[176:191]
    v_mov_b32 v72, 0
    v_mov_b32 v73, 0
    v_mov_b32 v74, 0
    v_mov_b32 v75, 0
    ds_read_b64_tr_b16 v[204:205], v8 offset:15360
    ds_read_b64_tr_b16 v[206:207], v8 offset:15616
    s_waitcnt lgkmcnt(6)
    v_mfma_f32_32x32x16_bf16 v[176:191], v[192:195], v[80:83], v[176:191]
    v_mov_b32 v76, 0
    v_mov_b32 v77, 0
    v_mov_b32 v78, 0
    v_mov_b32 v79, 0
    ds_read_b64_tr_b16 v[192:193], v8 offset:16384
    ds_read_b64_tr_b16 v[194:195], v8 offset:16640
    s_waitcnt lgkmcnt(6)
    v_mfma_f32_32x32x16_bf16 v[176:191], v[196:199], v[84:87], v[176:191]
    v_mov_b32 v80, 0
    v_mov_b32 v81, 0
    v_mov_b32 v82, 0
    v_mov_b32 v83, 0
    ds_read_b64_tr_b16 v[196:197], v8 offset:17408
    ds_read_b64_tr_b16 v[198:199], v8 offset:17664
    s_waitcnt lgkmcnt(6)
    v_mfma_f32_32x32x16_bf16 v[176:191], v[200:203], v[88:91], v[176:191]
    v_mov_b32 v84, 0
    v_mov_b32 v85, 0
    v_mov_b32 v86, 0
    v_mov_b32 v87, 0
    ds_read_b64_tr_b16 v[200:201], v8 offset:18432
    ds_read_b64_tr_b16 v[202:203], v8 offset:18688
    s_waitcnt lgkmcnt(6)
    v_mfma_f32_32x32x16_bf16 v[176:191], v[204:207], v[92:95], v[176:191]
    v_mov_b32 v88, 0
    v_mov_b32 v89, 0
    v_mov_b32 v90, 0
    v_mov_b32 v91, 0
    ds_read_b64_tr_b16 v[204:205], v8 offset:19456
    ds_read_b64_tr_b16 v[206:207], v8 offset:19712
    s_waitcnt lgkmcnt(6)
    v_mfma_f32_32x32x16_bf16 v[176:191], v[192:195], v[96:99], v[176:191]
    v_mov_b32 v92, 0
    v_mov_b32 v93, 0
    v_mov_b32 v94, 0
    v_mov_b32 v95, 0
    ds_read_b64_tr_b16 v[192:193], v8 offset:20480
    ds_read_b64_tr_b16 v[194:195], v8 offset:20736
    s_waitcnt lgkmcnt(6)
    v_mfma_f32_32x32x16_bf16 v[176:191], v[196:199], v[100:103], v[176:191]
    v_mov_b32 v96, 0
    v_mov_b32 v97, 0
    v_mov_b32 v98, 0
    v_mov_b32 v99, 0
    ds_read_b64_tr_b16 v[196:197], v8 offset:21504
    ds_read_b64_tr_b16 v[198:199], v8 offset:21760
    s_waitcnt lgkmcnt(6)
    v_mfma_f32_32x32x16_bf16 v[176:191], v[200:203], v[104:107], v[176:191]
    v_mov_b32 v100, 0
    v_mov_b32 v101, 0
    v_mov_b32 v102, 0
    v_mov_b32 v103, 0
    ds_read_b64_tr_b16 v[200:201], v8 offset:22528
    ds_read_b64_tr_b16 v[202:203], v8 offset:22784
    s_waitcnt lgkmcnt(6)
    v_mfma_f32_32x32x16_bf16 v[176:191], v[204:207], v[108:111], v[176:191]
    v_mov_b32 v104, 0
    v_mov_b32 v105, 0
    v_mov_b32 v106, 0
    v_mov_b32 v107, 0
    ds_read_b64_tr_b16 v[204:205], v8 offset:23552
    ds_read_b64_tr_b16 v[206:207], v8 offset:23808
    s_waitcnt lgkmcnt(6)
    v_mfma_f32_32x32x16_bf16 v[176:191], v[192:195], v[112:115], v[176:191]
    v_mov_b32 v108, 0
    v_mov_b32 v109, 0
    v_mov_b32 v110, 0
    v_mov_b32 v111, 0
    ds_read_b64_tr_b16 v[192:193], v8 offset:24576
    ds_read_b64_tr_b16 v[194:195], v8 offset:24832
    s_waitcnt lgkmcnt(6)
    v_mfma_f32_32x32x16_bf16 v[176:191], v[196:199], v[116:119], v[176:191]
    v_mov_b32 v112, 0
    v_mov_b32 v113, 0
    v_mov_b32 v114, 0
    v_mov_b32 v115, 0
    ds_read_b64_tr_b16 v[196:197], v8 offset:25600
    ds_read_b64_tr_b16 v[198:199], v8 offset:25856
    s_waitcnt lgkmcnt(6)
    v_mfma_f32_32x32x16_bf16 v[176:191], v[200:203], v[120:123], v[176:191]
    v_mov_b32 v116, 0
    v_mov_b32 v117, 0
    v_mov_b32 v118, 0
    v_mov_b32 v119, 0
    ds_read_b64_tr_b16 v[200:201], v8 offset:26624
    ds_read_b64_tr_b16 v[202:203], v8 offset:26880
    s_waitcnt lgkmcnt(6)
    v_mfma_f32_32x32x16_bf16 v[176:191], v[204:207], v[124:127], v[176:191]
    v_mov_b32 v120, 0
    v_mov_b32 v121, 0
    v_mov_b32 v122, 0
    v_mov_b32 v123, 0
    ds_read_b64_tr_b16 v[204:205], v8 offset:27648
    ds_read_b64_tr_b16 v[206:207], v8 offset:27904
    s_waitcnt lgkmcnt(6)
    v_mfma_f32_32x32x16_bf16 v[176:191], v[192:195], v[128:131], v[176:191]
    v_mov_b32 v124, 0
    v_mov_b32 v125, 0
    v_mov_b32 v126, 0
    v_mov_b32 v127, 0
    s_waitcnt lgkmcnt(4)
    v_mfma_f32_32x32x16_bf16 v[176:191], v[196:199], v[132:135], v[176:191]
    s_waitcnt lgkmcnt(2)
    v_mfma_f32_32x32x16_bf16 v[176:191], v[200:203], v[136:139], v[176:191]
    s_waitcnt lgkmcnt(0)
    v_mfma_f32_32x32x16_bf16 v[176:191], v[204:207], v[140:143], v[176:191]
    s_waitcnt vmcnt(0)
    v_mov_b32 v14, 1
    s_add_u32 s54, s3, s87
    s_add_u32 s53, s51, s54
    s_add_u32 s53, s53, 0x00018000
    s_mov_b64 exec, 1
    buffer_atomic_add v14, off, s[28:31], s53 sc1
    s_mov_b64 exec, -1
    s_nop 3
    v_pk_fma_f32 v[176:177], v[224:225], v[10:11], v[176:177] op_sel:[0,1,0] op_sel_hi:[1,1,1]
    v_pk_fma_f32 v[178:179], v[226:227], v[10:11], v[178:179] op_sel:[0,1,0] op_sel_hi:[1,1,1]
    v_pk_fma_f32 v[180:181], v[228:229], v[10:11], v[180:181] op_sel:[0,1,0] op_sel_hi:[1,1,1]
    v_pk_fma_f32 v[182:183], v[230:231], v[10:11], v[182:183] op_sel:[0,1,0] op_sel_hi:[1,1,1]
    v_pk_fma_f32 v[184:185], v[232:233], v[10:11], v[184:185] op_sel:[0,1,0] op_sel_hi:[1,1,1]
    v_pk_fma_f32 v[186:187], v[234:235], v[10:11], v[186:187] op_sel:[0,1,0] op_sel_hi:[1,1,1]
    v_pk_fma_f32 v[188:189], v[236:237], v[10:11], v[188:189] op_sel:[0,1,0] op_sel_hi:[1,1,1]
    v_pk_fma_f32 v[190:191], v[238:239], v[10:11], v[190:191] op_sel:[0,1,0] op_sel_hi:[1,1,1]
    v_mul_f32 v10, 0x3e8b97f6, v10
    v_pk_mul_f32 v[176:177], v[176:177], v[10:11] op_sel:[0,0] op_sel_hi:[1,0]
    v_pk_mul_f32 v[178:179], v[178:179], v[10:11] op_sel:[0,0] op_sel_hi:[1,0]
    v_pk_mul_f32 v[180:181], v[180:181], v[10:11] op_sel:[0,0] op_sel_hi:[1,0]
    v_pk_mul_f32 v[182:183], v[182:183], v[10:11] op_sel:[0,0] op_sel_hi:[1,0]
    v_pk_mul_f32 v[184:185], v[184:185], v[10:11] op_sel:[0,0] op_sel_hi:[1,0]
    v_pk_mul_f32 v[186:187], v[186:187], v[10:11] op_sel:[0,0] op_sel_hi:[1,0]
    v_pk_mul_f32 v[188:189], v[188:189], v[10:11] op_sel:[0,0] op_sel_hi:[1,0]
    v_pk_mul_f32 v[190:191], v[190:191], v[10:11] op_sel:[0,0] op_sel_hi:[1,0]
    v_cvt_pk_bf16_f32 v192, v176, v177
    v_cvt_pk_bf16_f32 v193, v178, v179
    v_cvt_pk_bf16_f32 v194, v180, v181
    v_cvt_pk_bf16_f32 v195, v182, v183
    v_cvt_pk_bf16_f32 v196, v184, v185
    v_cvt_pk_bf16_f32 v197, v186, v187
    v_cvt_pk_bf16_f32 v198, v188, v189
    v_cvt_pk_bf16_f32 v199, v190, v191
    v_pk_mul_f32 v[12:13], v[176:177], v[176:177]
    v_pk_fma_f32 v[12:13], v[178:179], v[178:179], v[12:13]
    v_pk_fma_f32 v[12:13], v[180:181], v[180:181], v[12:13]
    v_pk_fma_f32 v[12:13], v[182:183], v[182:183], v[12:13]
    v_pk_fma_f32 v[12:13], v[184:185], v[184:185], v[12:13]
    v_pk_fma_f32 v[12:13], v[186:187], v[186:187], v[12:13]
    v_pk_fma_f32 v[12:13], v[188:189], v[188:189], v[12:13]
    v_pk_fma_f32 v[12:13], v[190:191], v[190:191], v[12:13]
    v_add_f32 v14, v12, v13
    v_add_f32 v15, v12, v13
    s_nop 1
    v_permlane32_swap_b32 v14, v15
    v_add_f32 v14, v14, v15
    v_sqrt_f32 v14, v14
    s_mov_b32 exec_lo, 0
    s_mov_b32 exec_hi, -1
    v_mov_b32 v198, v14
    s_mov_b64 exec, -1
    s_lshl_b32 s53, s40, 11
    s_add_u32 s53, s53, 144384
    v_add_u32 v14, s53, v2
    ds_write_b128 v14, v[192:195]
    ds_write_b128 v14, v[196:199] offset:1024
    s_add_u32 s6, s51, s3
    s_add_u32 s6, s6, 98304
    v_mov_b32 v164, 0
    v_mov_b32 v212, 0
    v_mov_b32 v165, 0
    v_mov_b32 v213, 0
    v_mov_b32 v166, 0
    v_mov_b32 v214, 0
    v_mov_b32 v167, 0
    v_mov_b32 v215, 0
    s_add_u32 s53, s40, 1
    s_and_b32 s53, s53, 3
    s_mul_i32 s54, s53, 12288
    s_lshl_b32 s53, s53, 11
    s_add_u32 s53, s53, 144384
    v_add_u32 v144, s53, v2
    v_add_u32 v216, s54, v2
    s_add_u32 s53, s40, 2
    s_and_b32 s53, s53, 3
    s_mul_i32 s54, s53, 12288
    s_lshl_b32 s53, s53, 11
    s_add_u32 s53, s53, 144384
    v_add_u32 v145, s53, v2
    v_add_u32 v217, s54, v2
    s_add_u32 s53, s40, 3
    s_and_b32 s53, s53, 3
    s_mul_i32 s54, s53, 12288
    s_lshl_b32 s53, s53, 11
    s_add_u32 s53, s53, 144384
    v_add_u32 v146, s53, v2
    v_add_u32 v218, s54, v2
    s_add_u32 s53, s40, 4
    s_and_b32 s53, s53, 3
    s_mul_i32 s54, s53, 12288
    s_lshl_b32 s53, s53, 11
    s_add_u32 s53, s53, 144384
    v_add_u32 v147, s53, v2
    v_add_u32 v219, s54, v2
    s_lshl_b32 s95, s42, 18
    s_lshl_b32 s53, s40, 12
    s_add_u32 s95, s95, s53
    s_add_u32 s95, s95, s47
    s_add_u32 s95, s95, 0x00400000
    s_lshl_b32 s85, s41, 14
    s_add_u32 s85, s85, s95
    s_sub_u32 s94, s95, 0x4000
    s_mul_i32 s53, s46, 12
    s_add_u32 s53, s53, 163584
    v_mov_b32 v15, s53
    s_add_u32 s94, s94, 0x4000
    s_cmp_eq_u32 s94, s85
    s_cselect_b32 s53, 0x4000, 0
    s_add_u32 s94, s94, s53
    v_mov_b32 v10, 0x7f800000
    s_waitcnt lgkmcnt(0)
    s_barrier
    ds_read_b32 v14, v15
    ds_read_b128 v[32:35], v144
    ds_read_b128 v[36:39], v144 offset:1024
    ds_read_b128 v[40:43], v145
    ds_read_b128 v[44:47], v145 offset:1024
    ds_read_b128 v[48:51], v146
    ds_read_b128 v[52:55], v146 offset:1024
    ds_read_b128 v[56:59], v147
    ds_read_b128 v[60:63], v147 offset:1024
    buffer_load_dwordx4 v[168:171], v2, s[28:31], s94 offen offset:0 sc1
    buffer_load_dwordx4 v[172:175], v2, s[28:31], s94 offen offset:1024 sc1
    buffer_load_dwordx4 v[176:179], v2, s[28:31], s94 offen offset:2048 sc1
    buffer_load_dwordx4 v[180:183], v2, s[28:31], s94 offen offset:3072 sc1
    s_add_u32 s94, s94, 0x4000
    s_cmp_eq_u32 s94, s85
    s_cselect_b32 s53, 0x4000, 0
    s_add_u32 s94, s94, s53
    buffer_load_dwordx4 v[184:187], v2, s[28:31], s94 offen offset:0 sc1
    buffer_load_dwordx4 v[188:191], v2, s[28:31], s94 offen offset:1024 sc1
    buffer_load_dwordx4 v[192:195], v2, s[28:31], s94 offen offset:2048 sc1
    buffer_load_dwordx4 v[196:199], v2, s[28:31], s94 offen offset:3072 sc1
    s_add_u32 s94, s94, 0x4000
    s_cmp_eq_u32 s94, s85
    s_cselect_b32 s53, 0x4000, 0
    s_add_u32 s94, s94, s53
    s_waitcnt lgkmcnt(6)
    v_sqrt_f32 v14, v14
    v_mov_b32 v15, 0x42700000
    v_mfma_f32_32x32x16_bf16 v[128:143], v[240:243], v[32:35], 0
    s_mov_b32 exec_lo, 0
    s_mov_b32 exec_hi, -1
    v_fma_f32 v38, -v38, v14, v15
    v_cvt_pk_bf16_f32 v38, v38, 0
    s_waitcnt lgkmcnt(4)
    v_fma_f32 v46, -v46, v14, v15
    v_cvt_pk_bf16_f32 v46, v46, 0
    s_waitcnt lgkmcnt(2)
    v_fma_f32 v54, -v54, v14, v15
    v_cvt_pk_bf16_f32 v54, v54, 0
    s_waitcnt lgkmcnt(0)
    v_fma_f32 v62, -v62, v14, v15
    v_cvt_pk_bf16_f32 v62, v62, 0
    s_mov_b64 exec, -1
    v_mfma_f32_32x32x16_bf16 v[128:143], v[244:247], v[36:39], v[128:143]
    s_mov_b32 s93, 3
    s_mov_b32 s96, 0
    s_nop 9
L_att:
    v_exp_f32 v128, v128
    v_exp_f32 v129, v129
    v_mfma_f32_32x32x16_bf16 v[112:127], v[212:215], v[164:167], v[112:127]
    v_exp_f32 v130, v130
    v_exp_f32 v131, v131
    v_exp_f32 v132, v132
    v_exp_f32 v133, v133
    v_mfma_f32_32x32x16_bf16 v[144:159], v[240:243], v[40:43], 0
    v_exp_f32 v134, v134
    v_exp_f32 v135, v135
    v_cvt_pk_bf16_f32 v160, v128, v129
    v_cvt_pk_bf16_f32 v161, v130, v131
    v_cvt_pk_bf16_f32 v162, v132, v133
    v_mfma_f32_32x32x16_bf16 v[144:159], v[244:247], v[44:47], v[144:159]
    v_cvt_pk_bf16_f32 v163, v134, v135
    v_exp_f32 v136, v136
    v_exp_f32 v137, v137
    v_exp_f32 v138, v138
    v_exp_f32 v139, v139
    v_mfma_f32_32x32x16_bf16 v[64:79], v[248:251], v[160:163], v[64:79]
    buffer_load_dwordx4 v[200:203], v2, s[28:31], s94 offen offset:0 sc1
    v_exp_f32 v140, v140
    v_exp_f32 v141, v141
    v_exp_f32 v142, v142
    v_exp_f32 v143, v143
    v_cvt_pk_bf16_f32 v164, v136, v137
    v_cvt_pk_bf16_f32 v165, v138, v139
    v_cvt_pk_bf16_f32 v166, v140, v141
    v_cvt_pk_bf16_f32 v167, v142, v143
    v_exp_f32 v144, v144
    v_exp_f32 v145, v145
    v_mfma_f32_32x32x16_bf16 v[64:79], v[252:255], v[164:167], v[64:79]
    v_exp_f32 v146, v146
    v_exp_f32 v147, v147
    v_exp_f32 v148, v148
    v_exp_f32 v149, v149
    v_mfma_f32_32x32x16_bf16 v[128:143], v[240:243], v[48:51], 0
    v_exp_f32 v150, v150
    v_exp_f32 v151, v151
    v_cvt_pk_bf16_f32 v160, v144, v145
    v_cvt_pk_bf16_f32 v161, v146, v147
    v_cvt_pk_bf16_f32 v162, v148, v149
    v_mfma_f32_32x32x16_bf16 v[128:143], v[244:247], v[52:55], v[128:143]
    v_cvt_pk_bf16_f32 v163, v150, v151
    v_exp_f32 v152, v152
    v_exp_f32 v153, v153
    v_exp_f32 v154, v154
    v_exp_f32 v155, v155
    v_mfma_f32_32x32x16_bf16 v[80:95], v[248:251], v[160:163], v[80:95]
    buffer_load_dwordx4 v[204:207], v2, s[28:31], s94 offen offset:1024 sc1
    v_exp_f32 v156, v156
    v_exp_f32 v157, v157
    v_exp_f32 v158, v158
    v_exp_f32 v159, v159
    v_cvt_pk_bf16_f32 v164, v152, v153
    v_cvt_pk_bf16_f32 v165, v154, v155
    v_cvt_pk_bf16_f32 v166, v156, v157
    v_cvt_pk_bf16_f32 v167, v158, v159
    v_exp_f32 v128, v128
    v_exp_f32 v129, v129
    v_mfma_f32_32x32x16_bf16 v[80:95], v[252:255], v[164:167], v[80:95]
    v_exp_f32 v130, v130
    v_exp_f32 v131, v131
    v_exp_f32 v132, v132
    v_exp_f32 v133, v133
    v_mfma_f32_32x32x16_bf16 v[144:159], v[240:243], v[56:59], 0
    v_exp_f32 v134, v134
    v_exp_f32 v135, v135
    v_cvt_pk_bf16_f32 v160, v128, v129
    v_cvt_pk_bf16_f32 v161, v130, v131
    v_cvt_pk_bf16_f32 v162, v132, v133
    v_mfma_f32_32x32x16_bf16 v[144:159], v[244:247], v[60:63], v[144:159]
    v_cvt_pk_bf16_f32 v163, v134, v135
    v_exp_f32 v136, v136
    v_exp_f32 v137, v137
    v_exp_f32 v138, v138
    v_exp_f32 v139, v139
    v_mfma_f32_32x32x16_bf16 v[96:111], v[248:251], v[160:163], v[96:111]
    buffer_load_dwordx4 v[208:211], v2, s[28:31], s94 offen offset:2048 sc1
    v_exp_f32 v140, v140
    v_exp_f32 v141, v141
    v_exp_f32 v142, v142
    v_exp_f32 v143, v143
    v_cvt_pk_bf16_f32 v164, v136, v137
    v_cvt_pk_bf16_f32 v165, v138, v139
    v_cvt_pk_bf16_f32 v166, v140, v141
    v_cvt_pk_bf16_f32 v167, v142, v143
    v_exp_f32 v144, v144
    v_exp_f32 v145, v145
    v_mfma_f32_32x32x16_bf16 v[96:111], v[252:255], v[164:167], v[96:111]
    v_exp_f32 v146, v146
    v_exp_f32 v147, v147
    v_exp_f32 v148, v148
    v_exp_f32 v149, v149
    s_waitcnt vmcnt(7)
    v_mfma_f32_32x32x16_bf16 v[128:143], v[168:171], v[32:35], 0
    v_exp_f32 v150, v150
    v_exp_f32 v151, v151
    v_cvt_pk_bf16_f32 v160, v144, v145
    v_cvt_pk_bf16_f32 v161, v146, v147
    v_cvt_pk_bf16_f32 v162, v148, v149
    v_mfma_f32_32x32x16_bf16 v[128:143], v[172:175], v[36:39], v[128:143]
    v_cvt_pk_bf16_f32 v163, v150, v151
    v_exp_f32 v152, v152
    v_exp_f32 v153, v153
    v_exp_f32 v154, v154
    v_exp_f32 v155, v155
    v_mfma_f32_32x32x16_bf16 v[112:127], v[248:251], v[160:163], v[112:127]
    buffer_load_dwordx4 v[212:215], v2, s[28:31], s94 offen offset:3072 sc1
    s_add_u32 s94, s94, 0x4000
    s_cmp_eq_u32 s94, s85
    s_cselect_b32 s53, 0x4000, 0
    s_add_u32 s94, s94, s53
    v_exp_f32 v156, v156
    v_exp_f32 v157, v157
    v_exp_f32 v158, v158
    v_exp_f32 v159, v159
    v_cvt_pk_bf16_f32 v164, v152, v153
    v_cvt_pk_bf16_f32 v165, v154, v155
    v_cvt_pk_bf16_f32 v166, v156, v157
    v_cvt_pk_bf16_f32 v167, v158, v159
    v_exp_f32 v128, v128
    v_exp_f32 v129, v129
    v_mfma_f32_32x32x16_bf16 v[112:127], v[252:255], v[164:167], v[112:127]
    v_exp_f32 v130, v130
    v_exp_f32 v131, v131
    v_exp_f32 v132, v132
    v_exp_f32 v133, v133
    v_mfma_f32_32x32x16_bf16 v[144:159], v[168:171], v[40:43], 0
    v_exp_f32 v134, v134
    v_exp_f32 v135, v135
    v_cvt_pk_bf16_f32 v160, v128, v129
    v_cvt_pk_bf16_f32 v161, v130, v131
    v_cvt_pk_bf16_f32 v162, v132, v133
    v_mfma_f32_32x32x16_bf16 v[144:159], v[172:175], v[44:47], v[144:159]
    v_cvt_pk_bf16_f32 v163, v134, v135
    v_exp_f32 v136, v136
    v_exp_f32 v137, v137
    v_exp_f32 v138, v138
    v_exp_f32 v139, v139
    v_mfma_f32_32x32x16_bf16 v[64:79], v[176:179], v[160:163], v[64:79]
    buffer_load_dwordx4 v[240:243], v2, s[28:31], s94 offen offset:0 sc1
    v_exp_f32 v140, v140
    v_exp_f32 v141, v141
    v_exp_f32 v142, v142
    v_exp_f32 v143, v143
    v_cvt_pk_bf16_f32 v164, v136, v137
    v_cvt_pk_bf16_f32 v165, v138, v139
    v_cvt_pk_bf16_f32 v166, v140, v141
    v_cvt_pk_bf16_f32 v167, v142, v143
    v_exp_f32 v144, v144
    v_exp_f32 v145, v145
    v_mfma_f32_32x32x16_bf16 v[64:79], v[180:183], v[164:167], v[64:79]
    v_exp_f32 v146, v146
    v_exp_f32 v147, v147
    v_exp_f32 v148, v148
    v_exp_f32 v149, v149
    v_mfma_f32_32x32x16_bf16 v[128:143], v[168:171], v[48:51], 0
    v_exp_f32 v150, v150
    v_exp_f32 v151, v151
    v_cvt_pk_bf16_f32 v160, v144, v145
    v_cvt_pk_bf16_f32 v161, v146, v147
    v_cvt_pk_bf16_f32 v162, v148, v149
    v_mfma_f32_32x32x16_bf16 v[128:143], v[172:175], v[52:55], v[128:143]
    v_cvt_pk_bf16_f32 v163, v150, v151
    v_exp_f32 v152, v152
    v_exp_f32 v153, v153
    v_exp_f32 v154, v154
    v_exp_f32 v155, v155
    v_mfma_f32_32x32x16_bf16 v[80:95], v[176:179], v[160:163], v[80:95]
    buffer_load_dwordx4 v[244:247], v2, s[28:31], s94 offen offset:1024 sc1
    v_exp_f32 v156, v156
    v_exp_f32 v157, v157
    v_exp_f32 v158, v158
    v_exp_f32 v159, v159
    v_cvt_pk_bf16_f32 v164, v152, v153
    v_cvt_pk_bf16_f32 v165, v154, v155
    v_cvt_pk_bf16_f32 v166, v156, v157
    v_cvt_pk_bf16_f32 v167, v158, v159
    v_exp_f32 v128, v128
    v_exp_f32 v129, v129
    v_mfma_f32_32x32x16_bf16 v[80:95], v[180:183], v[164:167], v[80:95]
    v_exp_f32 v130, v130
    v_exp_f32 v131, v131
    v_exp_f32 v132, v132
    v_exp_f32 v133, v133
    v_mfma_f32_32x32x16_bf16 v[144:159], v[168:171], v[56:59], 0
    v_exp_f32 v134, v134
    v_exp_f32 v135, v135
    v_cvt_pk_bf16_f32 v160, v128, v129
    v_cvt_pk_bf16_f32 v161, v130, v131
    v_cvt_pk_bf16_f32 v162, v132, v133
    v_mfma_f32_32x32x16_bf16 v[144:159], v[172:175], v[60:63], v[144:159]
    v_cvt_pk_bf16_f32 v163, v134, v135
    v_exp_f32 v136, v136
    v_exp_f32 v137, v137
    v_exp_f32 v138, v138
    v_exp_f32 v139, v139
    v_mfma_f32_32x32x16_bf16 v[96:111], v[176:179], v[160:163], v[96:111]
    buffer_load_dwordx4 v[248:251], v2, s[28:31], s94 offen offset:2048 sc1
    v_exp_f32 v140, v140
    v_exp_f32 v141, v141
    v_exp_f32 v142, v142
    v_exp_f32 v143, v143
    v_cvt_pk_bf16_f32 v164, v136, v137
    v_cvt_pk_bf16_f32 v165, v138, v139
    v_cvt_pk_bf16_f32 v166, v140, v141
    v_cvt_pk_bf16_f32 v167, v142, v143
    v_exp_f32 v144, v144
    v_exp_f32 v145, v145
    v_mfma_f32_32x32x16_bf16 v[96:111], v[180:183], v[164:167], v[96:111]
    v_exp_f32 v146, v146
    v_exp_f32 v147, v147
    v_exp_f32 v148, v148
    v_exp_f32 v149, v149
    s_waitcnt vmcnt(7)
    v_mfma_f32_32x32x16_bf16 v[128:143], v[184:187], v[32:35], 0
    v_exp_f32 v150, v150
    v_exp_f32 v151, v151
    v_cvt_pk_bf16_f32 v160, v144, v145
    v_cvt_pk_bf16_f32 v161, v146, v147
    v_cvt_pk_bf16_f32 v162, v148, v149
    v_mfma_f32_32x32x16_bf16 v[128:143], v[188:191], v[36:39], v[128:143]
    v_cvt_pk_bf16_f32 v163, v150, v151
    v_exp_f32 v152, v152
    v_exp_f32 v153, v153
    v_exp_f32 v154, v154
    v_exp_f32 v155, v155
    v_mfma_f32_32x32x16_bf16 v[112:127], v[176:179], v[160:163], v[112:127]
    buffer_load_dwordx4 v[252:255], v2, s[28:31], s94 offen offset:3072 sc1
    s_add_u32 s94, s94, 0x4000
    s_cmp_eq_u32 s94, s85
    s_cselect_b32 s53, 0x4000, 0
    s_add_u32 s94, s94, s53
    v_exp_f32 v156, v156
    v_exp_f32 v157, v157
    v_exp_f32 v158, v158
    v_exp_f32 v159, v159
    v_cvt_pk_bf16_f32 v164, v152, v153
    v_cvt_pk_bf16_f32 v165, v154, v155
    v_cvt_pk_bf16_f32 v166, v156, v157
    v_cvt_pk_bf16_f32 v167, v158, v159
    v_exp_f32 v128, v128
    v_exp_f32 v129, v129
    v_mfma_f32_32x32x16_bf16 v[112:127], v[180:183], v[164:167], v[112:127]
    v_exp_f32 v130, v130
    v_exp_f32 v131, v131
    v_exp_f32 v132, v132
    v_exp_f32 v133, v133
    v_mfma_f32_32x32x16_bf16 v[144:159], v[184:187], v[40:43], 0
    v_exp_f32 v134, v134
    v_exp_f32 v135, v135
    v_cvt_pk_bf16_f32 v160, v128, v129
    v_cvt_pk_bf16_f32 v161, v130, v131
    v_cvt_pk_bf16_f32 v162, v132, v133
    v_mfma_f32_32x32x16_bf16 v[144:159], v[188:191], v[44:47], v[144:159]
    v_cvt_pk_bf16_f32 v163, v134, v135
    v_exp_f32 v136, v136
    v_exp_f32 v137, v137
    v_exp_f32 v138, v138
    v_exp_f32 v139, v139
    v_mfma_f32_32x32x16_bf16 v[64:79], v[192:195], v[160:163], v[64:79]
    buffer_load_dwordx4 v[168:171], v2, s[28:31], s94 offen offset:0 sc1
    v_exp_f32 v140, v140
    v_exp_f32 v141, v141
    v_exp_f32 v142, v142
    v_exp_f32 v143, v143
    v_cvt_pk_bf16_f32 v164, v136, v137
    v_cvt_pk_bf16_f32 v165, v138, v139
    v_cvt_pk_bf16_f32 v166, v140, v141
    v_cvt_pk_bf16_f32 v167, v142, v143
    v_exp_f32 v144, v144
    v_exp_f32 v145, v145
    v_mfma_f32_32x32x16_bf16 v[64:79], v[196:199], v[164:167], v[64:79]
    v_exp_f32 v146, v146
    v_exp_f32 v147, v147
    v_exp_f32 v148, v148
    v_exp_f32 v149, v149
    v_mfma_f32_32x32x16_bf16 v[128:143], v[184:187], v[48:51], 0
    v_exp_f32 v150, v150
    v_exp_f32 v151, v151
    v_cvt_pk_bf16_f32 v160, v144, v145
    v_cvt_pk_bf16_f32 v161, v146, v147
    v_cvt_pk_bf16_f32 v162, v148, v149
    v_mfma_f32_32x32x16_bf16 v[128:143], v[188:191], v[52:55], v[128:143]
    v_cvt_pk_bf16_f32 v163, v150, v151
    v_exp_f32 v152, v152
    v_exp_f32 v153, v153
    v_exp_f32 v154, v154
    v_exp_f32 v155, v155
    v_mfma_f32_32x32x16_bf16 v[80:95], v[192:195], v[160:163], v[80:95]
    buffer_load_dwordx4 v[172:175], v2, s[28:31], s94 offen offset:1024 sc1
    v_exp_f32 v156, v156
    v_exp_f32 v157, v157
    v_exp_f32 v158, v158
    v_exp_f32 v159, v159
    v_cvt_pk_bf16_f32 v164, v152, v153
    v_cvt_pk_bf16_f32 v165, v154, v155
    v_cvt_pk_bf16_f32 v166, v156, v157
    v_cvt_pk_bf16_f32 v167, v158, v159
    v_exp_f32 v128, v128
    v_exp_f32 v129, v129
    v_mfma_f32_32x32x16_bf16 v[80:95], v[196:199], v[164:167], v[80:95]
    v_exp_f32 v130, v130
    v_exp_f32 v131, v131
    v_exp_f32 v132, v132
    v_exp_f32 v133, v133
    v_mfma_f32_32x32x16_bf16 v[144:159], v[184:187], v[56:59], 0
    v_exp_f32 v134, v134
    v_exp_f32 v135, v135
    v_cvt_pk_bf16_f32 v160, v128, v129
    v_cvt_pk_bf16_f32 v161, v130, v131
    v_cvt_pk_bf16_f32 v162, v132, v133
    v_mfma_f32_32x32x16_bf16 v[144:159], v[188:191], v[60:63], v[144:159]
    v_cvt_pk_bf16_f32 v163, v134, v135
    v_exp_f32 v136, v136
    v_exp_f32 v137, v137
    v_exp_f32 v138, v138
    v_exp_f32 v139, v139
    v_mfma_f32_32x32x16_bf16 v[96:111], v[192:195], v[160:163], v[96:111]
    buffer_load_dwordx4 v[176:179], v2, s[28:31], s94 offen offset:2048 sc1
    v_exp_f32 v140, v140
    v_exp_f32 v141, v141
    v_exp_f32 v142, v142
    v_exp_f32 v143, v143
    v_cvt_pk_bf16_f32 v164, v136, v137
    v_cvt_pk_bf16_f32 v165, v138, v139
    v_cvt_pk_bf16_f32 v166, v140, v141
    v_cvt_pk_bf16_f32 v167, v142, v143
    v_exp_f32 v144, v144
    v_exp_f32 v145, v145
    v_mfma_f32_32x32x16_bf16 v[96:111], v[196:199], v[164:167], v[96:111]
    v_exp_f32 v146, v146
    v_exp_f32 v147, v147
    v_exp_f32 v148, v148
    v_exp_f32 v149, v149
    s_waitcnt vmcnt(7)
    v_mfma_f32_32x32x16_bf16 v[128:143], v[200:203], v[32:35], 0
    v_exp_f32 v150, v150
    v_exp_f32 v151, v151
    v_cvt_pk_bf16_f32 v160, v144, v145
    v_cvt_pk_bf16_f32 v161, v146, v147
    v_cvt_pk_bf16_f32 v162, v148, v149
    v_mfma_f32_32x32x16_bf16 v[128:143], v[204:207], v[36:39], v[128:143]
    v_cvt_pk_bf16_f32 v163, v150, v151
    v_exp_f32 v152, v152
    v_exp_f32 v153, v153
    v_exp_f32 v154, v154
    v_exp_f32 v155, v155
    v_mfma_f32_32x32x16_bf16 v[112:127], v[192:195], v[160:163], v[112:127]
    buffer_load_dwordx4 v[180:183], v2, s[28:31], s94 offen offset:3072 sc1
    s_add_u32 s94, s94, 0x4000
    s_cmp_eq_u32 s94, s85
    s_cselect_b32 s53, 0x4000, 0
    s_add_u32 s94, s94, s53
    v_exp_f32 v156, v156
    v_exp_f32 v157, v157
    v_exp_f32 v158, v158
    v_exp_f32 v159, v159
    v_cvt_pk_bf16_f32 v164, v152, v153
    v_cvt_pk_bf16_f32 v165, v154, v155
    v_cvt_pk_bf16_f32 v166, v156, v157
    v_cvt_pk_bf16_f32 v167, v158, v159
    v_exp_f32 v128, v128
    v_exp_f32 v129, v129
    v_mfma_f32_32x32x16_bf16 v[112:127], v[196:199], v[164:167], v[112:127]
    v_exp_f32 v130, v130
    v_exp_f32 v131, v131
    v_exp_f32 v132, v132
    v_exp_f32 v133, v133
    v_mfma_f32_32x32x16_bf16 v[144:159], v[200:203], v[40:43], 0
    v_exp_f32 v134, v134
    v_exp_f32 v135, v135
    v_cvt_pk_bf16_f32 v160, v128, v129
    v_cvt_pk_bf16_f32 v161, v130, v131
    v_cvt_pk_bf16_f32 v162, v132, v133
    v_mfma_f32_32x32x16_bf16 v[144:159], v[204:207], v[44:47], v[144:159]
    v_cvt_pk_bf16_f32 v163, v134, v135
    v_exp_f32 v136, v136
    v_exp_f32 v137, v137
    v_exp_f32 v138, v138
    v_exp_f32 v139, v139
    v_mfma_f32_32x32x16_bf16 v[64:79], v[208:211], v[160:163], v[64:79]
    buffer_load_dwordx4 v[184:187], v2, s[28:31], s94 offen offset:0 sc1
    v_exp_f32 v140, v140
    v_exp_f32 v141, v141
    v_exp_f32 v142, v142
    v_exp_f32 v143, v143
    v_cvt_pk_bf16_f32 v164, v136, v137
    v_cvt_pk_bf16_f32 v165, v138, v139
    v_cvt_pk_bf16_f32 v166, v140, v141
    v_cvt_pk_bf16_f32 v167, v142, v143
    v_exp_f32 v144, v144
    v_exp_f32 v145, v145
    v_mfma_f32_32x32x16_bf16 v[64:79], v[212:215], v[164:167], v[64:79]
    v_exp_f32 v146, v146
    v_exp_f32 v147, v147
    v_exp_f32 v148, v148
    v_exp_f32 v149, v149
    v_mfma_f32_32x32x16_bf16 v[128:143], v[200:203], v[48:51], 0
    v_exp_f32 v150, v150
    v_exp_f32 v151, v151
    v_cvt_pk_bf16_f32 v160, v144, v145
    v_cvt_pk_bf16_f32 v161, v146, v147
    v_cvt_pk_bf16_f32 v162, v148, v149
    v_mfma_f32_32x32x16_bf16 v[128:143], v[204:207], v[52:55], v[128:143]
    v_cvt_pk_bf16_f32 v163, v150, v151
    v_exp_f32 v152, v152
    v_exp_f32 v153, v153
    v_exp_f32 v154, v154
    v_exp_f32 v155, v155
    v_mfma_f32_32x32x16_bf16 v[80:95], v[208:211], v[160:163], v[80:95]
    buffer_load_dwordx4 v[188:191], v2, s[28:31], s94 offen offset:1024 sc1
    v_exp_f32 v156, v156
    v_exp_f32 v157, v157
    v_exp_f32 v158, v158
    v_exp_f32 v159, v159
    v_cvt_pk_bf16_f32 v164, v152, v153
    v_cvt_pk_bf16_f32 v165, v154, v155
    v_cvt_pk_bf16_f32 v166, v156, v157
    v_cvt_pk_bf16_f32 v167, v158, v159
    v_exp_f32 v128, v128
    v_exp_f32 v129, v129
    v_mfma_f32_32x32x16_bf16 v[80:95], v[212:215], v[164:167], v[80:95]
    v_exp_f32 v130, v130
    v_exp_f32 v131, v131
    v_exp_f32 v132, v132
    v_exp_f32 v133, v133
    v_mfma_f32_32x32x16_bf16 v[144:159], v[200:203], v[56:59], 0
    v_exp_f32 v134, v134
    v_exp_f32 v135, v135
    v_cvt_pk_bf16_f32 v160, v128, v129
    v_cvt_pk_bf16_f32 v161, v130, v131
    v_cvt_pk_bf16_f32 v162, v132, v133
    v_mfma_f32_32x32x16_bf16 v[144:159], v[204:207], v[60:63], v[144:159]
    v_cvt_pk_bf16_f32 v163, v134, v135
    v_exp_f32 v136, v136
    v_exp_f32 v137, v137
    v_exp_f32 v138, v138
    v_exp_f32 v139, v139
    v_mfma_f32_32x32x16_bf16 v[96:111], v[208:211], v[160:163], v[96:111]
    buffer_load_dwordx4 v[192:195], v2, s[28:31], s94 offen offset:2048 sc1
    v_exp_f32 v140, v140
    v_exp_f32 v141, v141
    v_exp_f32 v142, v142
    v_exp_f32 v143, v143
    v_cvt_pk_bf16_f32 v164, v136, v137
    v_cvt_pk_bf16_f32 v165, v138, v139
    v_cvt_pk_bf16_f32 v166, v140, v141
    v_cvt_pk_bf16_f32 v167, v142, v143
    v_exp_f32 v144, v144
    v_exp_f32 v145, v145
    v_mfma_f32_32x32x16_bf16 v[96:111], v[212:215], v[164:167], v[96:111]
    v_exp_f32 v146, v146
    v_exp_f32 v147, v147
    v_exp_f32 v148, v148
    v_exp_f32 v149, v149
    s_waitcnt vmcnt(7)
    v_mfma_f32_32x32x16_bf16 v[128:143], v[240:243], v[32:35], 0
    v_exp_f32 v150, v150
    v_exp_f32 v151, v151
    v_cvt_pk_bf16_f32 v160, v144, v145
    v_cvt_pk_bf16_f32 v161, v146, v147
    v_cvt_pk_bf16_f32 v162, v148, v149
    v_mfma_f32_32x32x16_bf16 v[128:143], v[244:247], v[36:39], v[128:143]
    v_cvt_pk_bf16_f32 v163, v150, v151
    v_exp_f32 v152, v152
    v_exp_f32 v153, v153
    v_exp_f32 v154, v154
    v_exp_f32 v155, v155
    v_mfma_f32_32x32x16_bf16 v[112:127], v[208:211], v[160:163], v[112:127]
    buffer_load_dwordx4 v[196:199], v2, s[28:31], s94 offen offset:3072 sc1
    s_add_u32 s94, s94, 0x4000
    s_cmp_eq_u32 s94, s85
    s_cselect_b32 s53, 0x4000, 0
    s_add_u32 s94, s94, s53
    v_exp_f32 v156, v156
    v_exp_f32 v157, v157
    v_exp_f32 v158, v158
    v_exp_f32 v159, v159
    v_cvt_pk_bf16_f32 v164, v152, v153
    v_cvt_pk_bf16_f32 v165, v154, v155
    v_cvt_pk_bf16_f32 v166, v156, v157
    v_cvt_pk_bf16_f32 v167, v158, v159
    s_sub_u32 s93, s93, 1
    s_cmp_lg_u32 s93, 0
    s_cbranch_scc1 L_att
    v_exp_f32 v128, v128
    v_exp_f32 v129, v129
    v_mfma_f32_32x32x16_bf16 v[112:127], v[212:215], v[164:167], v[112:127]
    v_exp_f32 v130, v130
    v_exp_f32 v131, v131
    v_exp_f32 v132, v132
    v_exp_f32 v133, v133
    v_mfma_f32_32x32x16_bf16 v[144:159], v[240:243], v[40:43], 0
    v_exp_f32 v134, v134
    v_exp_f32 v135, v135
    v_cvt_pk_bf16_f32 v160, v128, v129
    v_cvt_pk_bf16_f32 v161, v130, v131
    v_cvt_pk_bf16_f32 v162, v132, v133
    v_mfma_f32_32x32x16_bf16 v[144:159], v[244:247], v[44:47], v[144:159]
    v_cvt_pk_bf16_f32 v163, v134, v135
    v_exp_f32 v136, v136
    v_exp_f32 v137, v137
    v_exp_f32 v138, v138
    v_exp_f32 v139, v139
    v_mfma_f32_32x32x16_bf16 v[64:79], v[248:251], v[160:163], v[64:79]
    buffer_load_dwordx4 v[200:203], v2, s[28:31], s94 offen offset:0 sc1
    v_exp_f32 v140, v140
    v_exp_f32 v141, v141
    v_exp_f32 v142, v142
    v_exp_f32 v143, v143
    v_cvt_pk_bf16_f32 v164, v136, v137
    v_cvt_pk_bf16_f32 v165, v138, v139
    v_cvt_pk_bf16_f32 v166, v140, v141
    v_cvt_pk_bf16_f32 v167, v142, v143
    v_exp_f32 v144, v144
    v_exp_f32 v145, v145
    v_mfma_f32_32x32x16_bf16 v[64:79], v[252:255], v[164:167], v[64:79]
    v_exp_f32 v146, v146
    v_exp_f32 v147, v147
    v_exp_f32 v148, v148
    v_exp_f32 v149, v149
    v_mfma_f32_32x32x16_bf16 v[128:143], v[240:243], v[48:51], 0
    v_exp_f32 v150, v150
    v_exp_f32 v151, v151
    v_cvt_pk_bf16_f32 v160, v144, v145
    v_cvt_pk_bf16_f32 v161, v146, v147
    v_cvt_pk_bf16_f32 v162, v148, v149
    v_mfma_f32_32x32x16_bf16 v[128:143], v[244:247], v[52:55], v[128:143]
    v_cvt_pk_bf16_f32 v163, v150, v151
    v_exp_f32 v152, v152
    v_exp_f32 v153, v153
    v_exp_f32 v154, v154
    v_exp_f32 v155, v155
    v_mfma_f32_32x32x16_bf16 v[80:95], v[248:251], v[160:163], v[80:95]
    buffer_load_dwordx4 v[204:207], v2, s[28:31], s94 offen offset:1024 sc1
    v_exp_f32 v156, v156
    v_exp_f32 v157, v157
    v_exp_f32 v158, v158
    v_exp_f32 v159, v159
    v_cvt_pk_bf16_f32 v164, v152, v153
    v_cvt_pk_bf16_f32 v165, v154, v155
    v_cvt_pk_bf16_f32 v166, v156, v157
    v_cvt_pk_bf16_f32 v167, v158, v159
    v_exp_f32 v128, v128
    v_exp_f32 v129, v129
    v_mfma_f32_32x32x16_bf16 v[80:95], v[252:255], v[164:167], v[80:95]
    v_exp_f32 v130, v130
    v_exp_f32 v131, v131
    v_exp_f32 v132, v132
    v_exp_f32 v133, v133
    v_mfma_f32_32x32x16_bf16 v[144:159], v[240:243], v[56:59], 0
    v_exp_f32 v134, v134
    v_exp_f32 v135, v135
    v_cvt_pk_bf16_f32 v160, v128, v129
    v_cvt_pk_bf16_f32 v161, v130, v131
    v_cvt_pk_bf16_f32 v162, v132, v133
    v_mfma_f32_32x32x16_bf16 v[144:159], v[244:247], v[60:63], v[144:159]
    v_cvt_pk_bf16_f32 v163, v134, v135
    v_exp_f32 v136, v136
    v_exp_f32 v137, v137
    v_exp_f32 v138, v138
    v_exp_f32 v139, v139
    v_mfma_f32_32x32x16_bf16 v[96:111], v[248:251], v[160:163], v[96:111]
    buffer_load_dwordx4 v[208:211], v2, s[28:31], s94 offen offset:2048 sc1
    v_exp_f32 v140, v140
    v_exp_f32 v141, v141
    v_exp_f32 v142, v142
    v_exp_f32 v143, v143
    v_cvt_pk_bf16_f32 v164, v136, v137
    v_cvt_pk_bf16_f32 v165, v138, v139
    v_cvt_pk_bf16_f32 v166, v140, v141
    v_cvt_pk_bf16_f32 v167, v142, v143
    v_exp_f32 v144, v144
    v_exp_f32 v145, v145
    v_mfma_f32_32x32x16_bf16 v[96:111], v[252:255], v[164:167], v[96:111]
    v_exp_f32 v146, v146
    v_exp_f32 v147, v147
    v_exp_f32 v148, v148
    v_exp_f32 v149, v149
    s_waitcnt vmcnt(7)
    v_mfma_f32_32x32x16_bf16 v[128:143], v[168:171], v[32:35], 0
    v_exp_f32 v150, v150
    v_exp_f32 v151, v151
    v_cvt_pk_bf16_f32 v160, v144, v145
    v_cvt_pk_bf16_f32 v161, v146, v147
    v_cvt_pk_bf16_f32 v162, v148, v149
    v_mfma_f32_32x32x16_bf16 v[128:143], v[172:175], v[36:39], v[128:143]
    v_cvt_pk_bf16_f32 v163, v150, v151
    v_exp_f32 v152, v152
    v_exp_f32 v153, v153
    v_exp_f32 v154, v154
    v_exp_f32 v155, v155
    v_mfma_f32_32x32x16_bf16 v[112:127], v[248:251], v[160:163], v[112:127]
    buffer_load_dwordx4 v[212:215], v2, s[28:31], s94 offen offset:3072 sc1
    s_add_u32 s94, s94, 0x4000
    s_cmp_eq_u32 s94, s85
    s_cselect_b32 s53, 0x4000, 0
    s_add_u32 s94, s94, s53
    v_exp_f32 v156, v156
    v_exp_f32 v157, v157
    v_exp_f32 v158, v158
    v_exp_f32 v159, v159
    v_cvt_pk_bf16_f32 v164, v152, v153
    v_cvt_pk_bf16_f32 v165, v154, v155
    v_cvt_pk_bf16_f32 v166, v156, v157
    v_cvt_pk_bf16_f32 v167, v158, v159
    v_exp_f32 v128, v128
    v_exp_f32 v129, v129
    v_mfma_f32_32x32x16_bf16 v[112:127], v[252:255], v[164:167], v[112:127]
    v_exp_f32 v130, v130
    v_exp_f32 v131, v131
    v_exp_f32 v132, v132
    v_exp_f32 v133, v133
    v_mfma_f32_32x32x16_bf16 v[144:159], v[168:171], v[40:43], 0
    v_exp_f32 v134, v134
    v_exp_f32 v135, v135
    v_cvt_pk_bf16_f32 v160, v128, v129
    v_cvt_pk_bf16_f32 v161, v130, v131
    v_cvt_pk_bf16_f32 v162, v132, v133
    v_mfma_f32_32x32x16_bf16 v[144:159], v[172:175], v[44:47], v[144:159]
    v_cvt_pk_bf16_f32 v163, v134, v135
    v_exp_f32 v136, v136
    v_exp_f32 v137, v137
    v_exp_f32 v138, v138
    v_exp_f32 v139, v139
    v_mfma_f32_32x32x16_bf16 v[64:79], v[176:179], v[160:163], v[64:79]
    v_exp_f32 v140, v140
    v_exp_f32 v141, v141
    v_exp_f32 v142, v142
    v_exp_f32 v143, v143
    v_cvt_pk_bf16_f32 v164, v136, v137
    v_cvt_pk_bf16_f32 v165, v138, v139
    v_cvt_pk_bf16_f32 v166, v140, v141
    v_cvt_pk_bf16_f32 v167, v142, v143
    v_exp_f32 v144, v144
    v_exp_f32 v145, v145
    v_mfma_f32_32x32x16_bf16 v[64:79], v[180:183], v[164:167], v[64:79]
    v_exp_f32 v146, v146
    v_exp_f32 v147, v147
    v_exp_f32 v148, v148
    v_exp_f32 v149, v149
    v_mfma_f32_32x32x16_bf16 v[128:143], v[168:171], v[48:51], 0
    v_exp_f32 v150, v150
    v_exp_f32 v151, v151
    v_cvt_pk_bf16_f32 v160, v144, v145
    v_cvt_pk_bf16_f32 v161, v146, v147
    v_cvt_pk_bf16_f32 v162, v148, v149
    v_mfma_f32_32x32x16_bf16 v[128:143], v[172:175], v[52:55], v[128:143]
    v_cvt_pk_bf16_f32 v163, v150, v151
    v_exp_f32 v152, v152
    v_exp_f32 v153, v153
    v_exp_f32 v154, v154
    v_exp_f32 v155, v155
    v_mfma_f32_32x32x16_bf16 v[80:95], v[176:179], v[160:163], v[80:95]
    v_exp_f32 v156, v156
    v_exp_f32 v157, v157
    v_exp_f32 v158, v158
    v_exp_f32 v159, v159
    v_cvt_pk_bf16_f32 v164, v152, v153
    v_cvt_pk_bf16_f32 v165, v154, v155
    v_cvt_pk_bf16_f32 v166, v156, v157
    v_cvt_pk_bf16_f32 v167, v158, v159
    v_exp_f32 v128, v128
    v_exp_f32 v129, v129
    v_mfma_f32_32x32x16_bf16 v[80:95], v[180:183], v[164:167], v[80:95]
    v_exp_f32 v130, v130
    v_exp_f32 v131, v131
    v_exp_f32 v132, v132
    v_exp_f32 v133, v133
    v_mfma_f32_32x32x16_bf16 v[144:159], v[168:171], v[56:59], 0
    v_exp_f32 v134, v134
    v_exp_f32 v135, v135
    v_cvt_pk_bf16_f32 v160, v128, v129
    v_cvt_pk_bf16_f32 v161, v130, v131
    v_cvt_pk_bf16_f32 v162, v132, v133
    v_mfma_f32_32x32x16_bf16 v[144:159], v[172:175], v[60:63], v[144:159]
    v_cvt_pk_bf16_f32 v163, v134, v135
    v_exp_f32 v136, v136
    v_exp_f32 v137, v137
    v_exp_f32 v138, v138
    v_exp_f32 v139, v139
    v_mfma_f32_32x32x16_bf16 v[96:111], v[176:179], v[160:163], v[96:111]
    v_exp_f32 v140, v140
    v_exp_f32 v141, v141
    v_exp_f32 v142, v142
    v_exp_f32 v143, v143
    v_cvt_pk_bf16_f32 v164, v136, v137
    v_cvt_pk_bf16_f32 v165, v138, v139
    v_cvt_pk_bf16_f32 v166, v140, v141
    v_cvt_pk_bf16_f32 v167, v142, v143
    v_exp_f32 v144, v144
    v_exp_f32 v145, v145
    v_mfma_f32_32x32x16_bf16 v[96:111], v[180:183], v[164:167], v[96:111]
    v_exp_f32 v146, v146
    v_exp_f32 v147, v147
    v_exp_f32 v148, v148
    v_exp_f32 v149, v149
    s_waitcnt vmcnt(4)
    v_mfma_f32_32x32x16_bf16 v[128:143], v[184:187], v[32:35], 0
    v_exp_f32 v150, v150
    v_exp_f32 v151, v151
    v_cvt_pk_bf16_f32 v160, v144, v145
    v_cvt_pk_bf16_f32 v161, v146, v147
    v_cvt_pk_bf16_f32 v162, v148, v149
    v_mfma_f32_32x32x16_bf16 v[128:143], v[188:191], v[36:39], v[128:143]
    v_cvt_pk_bf16_f32 v163, v150, v151
    v_exp_f32 v152, v152
    v_exp_f32 v153, v153
    v_exp_f32 v154, v154
    v_exp_f32 v155, v155
    v_mfma_f32_32x32x16_bf16 v[112:127], v[176:179], v[160:163], v[112:127]
    v_exp_f32 v156, v156
    v_exp_f32 v157, v157
    v_exp_f32 v158, v158
    v_exp_f32 v159, v159
    v_cvt_pk_bf16_f32 v164, v152, v153
    v_cvt_pk_bf16_f32 v165, v154, v155
    v_cvt_pk_bf16_f32 v166, v156, v157
    v_cvt_pk_bf16_f32 v167, v158, v159
    v_exp_f32 v128, v128
    v_exp_f32 v129, v129
    v_mfma_f32_32x32x16_bf16 v[112:127], v[180:183], v[164:167], v[112:127]
    v_exp_f32 v130, v130
    v_exp_f32 v131, v131
    v_exp_f32 v132, v132
    v_exp_f32 v133, v133
    v_mfma_f32_32x32x16_bf16 v[144:159], v[184:187], v[40:43], 0
    v_exp_f32 v134, v134
    v_exp_f32 v135, v135
    v_cvt_pk_bf16_f32 v160, v128, v129
    v_cvt_pk_bf16_f32 v161, v130, v131
    v_cvt_pk_bf16_f32 v162, v132, v133
    v_mfma_f32_32x32x16_bf16 v[144:159], v[188:191], v[44:47], v[144:159]
    v_cvt_pk_bf16_f32 v163, v134, v135
    v_exp_f32 v136, v136
    v_exp_f32 v137, v137
    v_exp_f32 v138, v138
    v_exp_f32 v139, v139
    v_mfma_f32_32x32x16_bf16 v[64:79], v[192:195], v[160:163], v[64:79]
    v_exp_f32 v140, v140
    v_exp_f32 v141, v141
    v_exp_f32 v142, v142
    v_exp_f32 v143, v143
    v_cvt_pk_bf16_f32 v164, v136, v137
    v_cvt_pk_bf16_f32 v165, v138, v139
    v_cvt_pk_bf16_f32 v166, v140, v141
    v_cvt_pk_bf16_f32 v167, v142, v143
    v_exp_f32 v144, v144
    v_exp_f32 v145, v145
    v_mfma_f32_32x32x16_bf16 v[64:79], v[196:199], v[164:167], v[64:79]
    v_exp_f32 v146, v146
    v_exp_f32 v147, v147
    v_exp_f32 v148, v148
    v_exp_f32 v149, v149
    v_mfma_f32_32x32x16_bf16 v[128:143], v[184:187], v[48:51], 0
    v_exp_f32 v150, v150
    v_exp_f32 v151, v151
    v_cvt_pk_bf16_f32 v160, v144, v145
    v_cvt_pk_bf16_f32 v161, v146, v147
    v_cvt_pk_bf16_f32 v162, v148, v149
    v_mfma_f32_32x32x16_bf16 v[128:143], v[188:191], v[52:55], v[128:143]
    v_cvt_pk_bf16_f32 v163, v150, v151
    v_exp_f32 v152, v152
    v_exp_f32 v153, v153
    v_exp_f32 v154, v154
    v_exp_f32 v155, v155
    v_mfma_f32_32x32x16_bf16 v[80:95], v[192:195], v[160:163], v[80:95]
    v_exp_f32 v156, v156
    v_exp_f32 v157, v157
    v_exp_f32 v158, v158
    v_exp_f32 v159, v159
    v_cvt_pk_bf16_f32 v164, v152, v153
    v_cvt_pk_bf16_f32 v165, v154, v155
    v_cvt_pk_bf16_f32 v166, v156, v157
    v_cvt_pk_bf16_f32 v167, v158, v159
    v_exp_f32 v128, v128
    v_exp_f32 v129, v129
    v_mfma_f32_32x32x16_bf16 v[80:95], v[196:199], v[164:167], v[80:95]
    v_exp_f32 v130, v130
    v_exp_f32 v131, v131
    v_exp_f32 v132, v132
    v_exp_f32 v133, v133
    v_mfma_f32_32x32x16_bf16 v[144:159], v[184:187], v[56:59], 0
    v_exp_f32 v134, v134
    v_exp_f32 v135, v135
    v_cvt_pk_bf16_f32 v160, v128, v129
    v_cvt_pk_bf16_f32 v161, v130, v131
    v_cvt_pk_bf16_f32 v162, v132, v133
    v_mfma_f32_32x32x16_bf16 v[144:159], v[188:191], v[60:63], v[144:159]
    v_cvt_pk_bf16_f32 v163, v134, v135
    v_exp_f32 v136, v136
    v_exp_f32 v137, v137
    v_exp_f32 v138, v138
    v_exp_f32 v139, v139
    v_mfma_f32_32x32x16_bf16 v[96:111], v[192:195], v[160:163], v[96:111]
    v_exp_f32 v140, v140
    v_exp_f32 v141, v141
    v_exp_f32 v142, v142
    v_exp_f32 v143, v143
    v_cvt_pk_bf16_f32 v164, v136, v137
    v_cvt_pk_bf16_f32 v165, v138, v139
    v_cvt_pk_bf16_f32 v166, v140, v141
    v_cvt_pk_bf16_f32 v167, v142, v143
    v_exp_f32 v144, v144
    v_exp_f32 v145, v145
    v_mfma_f32_32x32x16_bf16 v[96:111], v[196:199], v[164:167], v[96:111]
    v_exp_f32 v146, v146
    v_exp_f32 v147, v147
    v_exp_f32 v148, v148
    v_exp_f32 v149, v149
    s_waitcnt vmcnt(0)
    v_mfma_f32_32x32x16_bf16 v[128:143], v[200:203], v[32:35], 0
    v_exp_f32 v150, v150
    v_exp_f32 v151, v151
    v_cvt_pk_bf16_f32 v160, v144, v145
    v_cvt_pk_bf16_f32 v161, v146, v147
    v_cvt_pk_bf16_f32 v162, v148, v149
    v_mfma_f32_32x32x16_bf16 v[128:143], v[204:207], v[36:39], v[128:143]
    v_cvt_pk_bf16_f32 v163, v150, v151
    v_exp_f32 v152, v152
    v_exp_f32 v153, v153
    v_exp_f32 v154, v154
    v_exp_f32 v155, v155
    v_mfma_f32_32x32x16_bf16 v[112:127], v[192:195], v[160:163], v[112:127]
    v_exp_f32 v156, v156
    v_exp_f32 v157, v157
    v_exp_f32 v158, v158
    v_exp_f32 v159, v159
    v_cvt_pk_bf16_f32 v164, v152, v153
    v_cvt_pk_bf16_f32 v165, v154, v155
    v_cvt_pk_bf16_f32 v166, v156, v157
    v_cvt_pk_bf16_f32 v167, v158, v159
    v_exp_f32 v128, v128
    v_exp_f32 v129, v129
    v_mfma_f32_32x32x16_bf16 v[112:127], v[196:199], v[164:167], v[112:127]
    v_exp_f32 v130, v130
    v_exp_f32 v131, v131
    v_exp_f32 v132, v132
    v_exp_f32 v133, v133
    v_mfma_f32_32x32x16_bf16 v[144:159], v[200:203], v[40:43], 0
    v_exp_f32 v134, v134
    v_exp_f32 v135, v135
    v_cvt_pk_bf16_f32 v160, v128, v129
    v_cvt_pk_bf16_f32 v161, v130, v131
    v_cvt_pk_bf16_f32 v162, v132, v133
    v_mfma_f32_32x32x16_bf16 v[144:159], v[204:207], v[44:47], v[144:159]
    v_cvt_pk_bf16_f32 v163, v134, v135
    v_exp_f32 v136, v136
    v_exp_f32 v137, v137
    v_exp_f32 v138, v138
    v_exp_f32 v139, v139
    v_mfma_f32_32x32x16_bf16 v[64:79], v[208:211], v[160:163], v[64:79]
    v_exp_f32 v140, v140
    v_exp_f32 v141, v141
    v_exp_f32 v142, v142
    v_exp_f32 v143, v143
    v_cvt_pk_bf16_f32 v164, v136, v137
    v_cvt_pk_bf16_f32 v165, v138, v139
    v_cvt_pk_bf16_f32 v166, v140, v141
    v_cvt_pk_bf16_f32 v167, v142, v143
    v_exp_f32 v144, v144
    v_exp_f32 v145, v145
    v_mfma_f32_32x32x16_bf16 v[64:79], v[212:215], v[164:167], v[64:79]
    v_exp_f32 v146, v146
    v_exp_f32 v147, v147
    v_exp_f32 v148, v148
    v_exp_f32 v149, v149
    v_mfma_f32_32x32x16_bf16 v[128:143], v[200:203], v[48:51], 0
    v_exp_f32 v150, v150
    v_exp_f32 v151, v151
    v_cvt_pk_bf16_f32 v160, v144, v145
    v_cvt_pk_bf16_f32 v161, v146, v147
    v_cvt_pk_bf16_f32 v162, v148, v149
    v_mfma_f32_32x32x16_bf16 v[128:143], v[204:207], v[52:55], v[128:143]
    v_cvt_pk_bf16_f32 v163, v150, v151
    v_exp_f32 v152, v152
    v_exp_f32 v153, v153
    v_exp_f32 v154, v154
    v_exp_f32 v155, v155
    v_mfma_f32_32x32x16_bf16 v[80:95], v[208:211], v[160:163], v[80:95]
    v_exp_f32 v156, v156
    ds_write_b128 v216, v[64:67] offset:45056
    v_exp_f32 v157, v157
    ds_write_b128 v216, v[68:71] offset:46080
    v_exp_f32 v158, v158
    ds_write_b128 v216, v[72:75] offset:47104
    v_exp_f32 v159, v159
    ds_write_b128 v216, v[76:79] offset:48128
    v_cvt_pk_bf16_f32 v164, v152, v153
    v_cvt_pk_bf16_f32 v165, v154, v155
    v_cvt_pk_bf16_f32 v166, v156, v157
    v_cvt_pk_bf16_f32 v167, v158, v159
    v_exp_f32 v128, v128
    v_exp_f32 v129, v129
    v_mfma_f32_32x32x16_bf16 v[80:95], v[212:215], v[164:167], v[80:95]
    v_exp_f32 v130, v130
    v_exp_f32 v131, v131
    v_exp_f32 v132, v132
    v_exp_f32 v133, v133
    v_mfma_f32_32x32x16_bf16 v[144:159], v[200:203], v[56:59], 0
    v_exp_f32 v134, v134
    v_exp_f32 v135, v135
    v_cvt_pk_bf16_f32 v160, v128, v129
    v_cvt_pk_bf16_f32 v161, v130, v131
    v_cvt_pk_bf16_f32 v162, v132, v133
    v_mfma_f32_32x32x16_bf16 v[144:159], v[204:207], v[60:63], v[144:159]
    v_cvt_pk_bf16_f32 v163, v134, v135
    v_exp_f32 v136, v136
    v_exp_f32 v137, v137
    v_exp_f32 v138, v138
    v_exp_f32 v139, v139
    v_mfma_f32_32x32x16_bf16 v[96:111], v[208:211], v[160:163], v[96:111]
    v_exp_f32 v140, v140
    ds_write_b128 v217, v[80:83] offset:40960
    v_exp_f32 v141, v141
    ds_write_b128 v217, v[84:87] offset:41984
    v_exp_f32 v142, v142
    ds_write_b128 v217, v[88:91] offset:43008
    v_exp_f32 v143, v143
    ds_write_b128 v217, v[92:95] offset:44032
    v_cvt_pk_bf16_f32 v164, v136, v137
    v_cvt_pk_bf16_f32 v165, v138, v139
    v_cvt_pk_bf16_f32 v166, v140, v141
    v_cvt_pk_bf16_f32 v167, v142, v143
    v_exp_f32 v144, v144
    v_exp_f32 v145, v145
    v_mfma_f32_32x32x16_bf16 v[96:111], v[212:215], v[164:167], v[96:111]
    v_exp_f32 v146, v146
    v_exp_f32 v147, v147
    v_exp_f32 v148, v148
    v_exp_f32 v149, v149
    v_exp_f32 v150, v150
    v_exp_f32 v151, v151
    v_cvt_pk_bf16_f32 v160, v144, v145
    v_cvt_pk_bf16_f32 v161, v146, v147
    v_cvt_pk_bf16_f32 v162, v148, v149
    v_cvt_pk_bf16_f32 v163, v150, v151
    v_exp_f32 v152, v152
    v_exp_f32 v153, v153
    v_exp_f32 v154, v154
    v_exp_f32 v155, v155
    v_mfma_f32_32x32x16_bf16 v[112:127], v[208:211], v[160:163], v[112:127]
    v_exp_f32 v156, v156
    ds_write_b128 v218, v[96:99] offset:36864
    v_exp_f32 v157, v157
    ds_write_b128 v218, v[100:103] offset:37888
    v_exp_f32 v158, v158
    ds_write_b128 v218, v[104:107] offset:38912
    v_exp_f32 v159, v159
    ds_write_b128 v218, v[108:111] offset:39936
    v_cvt_pk_bf16_f32 v164, v152, v153
    v_cvt_pk_bf16_f32 v165, v154, v155
    v_cvt_pk_bf16_f32 v166, v156, v157
    v_cvt_pk_bf16_f32 v167, v158, v159
    s_nop 1
    v_mfma_f32_32x32x16_bf16 v[112:127], v[212:215], v[164:167], v[112:127]
    s_waitcnt lgkmcnt(0)
    s_barrier
    ds_read_b128 v[76:79], v219 offset:39936
    ds_read_b128 v[92:95], v219 offset:44032
    ds_read_b128 v[108:111], v219 offset:48128
    ds_read_b128 v[64:67], v219 offset:36864
    ds_read_b128 v[80:83], v219 offset:40960
    ds_read_b128 v[96:99], v219 offset:45056
    ds_read_b128 v[68:71], v219 offset:37888
    ds_read_b128 v[84:87], v219 offset:41984
    ds_read_b128 v[100:103], v219 offset:46080
    ds_read_b128 v[72:75], v219 offset:38912
    ds_read_b128 v[88:91], v219 offset:43008
    ds_read_b128 v[104:107], v219 offset:47104
    s_lshl_b32 s54, s48, 4
    s_add_u32 s54, s54, s42
    s_lshl_b32 s54, s54, 11
    s_add_u32 s54, s54, s47
    s_add_u32 s54, s54, 0x00200000
    v_mov_b32 v166, 0
    v_mov_b32 v167, 0
    v_mov_b32 v12, -1
    s_waitcnt lgkmcnt(9)
    v_pk_add_f32 v[76:77], v[76:77], v[92:93]
    v_pk_add_f32 v[124:125], v[124:125], v[108:109]
    v_pk_add_f32 v[78:79], v[78:79], v[94:95]
    v_pk_add_f32 v[126:127], v[126:127], v[110:111]
    v_pk_add_f32 v[124:125], v[124:125], v[76:77]
    v_pk_add_f32 v[126:127], v[126:127], v[78:79]
    v_mov_b32 v14, v124
    v_mov_b32 v15, v124
    s_waitcnt lgkmcnt(6)
    v_pk_add_f32 v[64:65], v[64:65], v[80:81]
    v_pk_add_f32 v[112:113], v[112:113], v[96:97]
    v_pk_add_f32 v[66:67], v[66:67], v[82:83]
    v_pk_add_f32 v[114:115], v[114:115], v[98:99]
    v_pk_add_f32 v[112:113], v[112:113], v[64:65]
    v_pk_add_f32 v[114:115], v[114:115], v[66:67]
    v_permlane32_swap_b32 v14, v15
    s_waitcnt lgkmcnt(3)
    v_rcp_f32 v14, v15
    v_cmp_nle_f32 vcc, 0x21800000, v15
    v_cmp_nlt_f32 s[62:63], v15, v10
    v_pk_add_f32 v[68:69], v[68:69], v[84:85]
    v_pk_add_f32 v[116:117], v[116:117], v[100:101]
    v_pk_add_f32 v[70:71], v[70:71], v[86:87]
    v_pk_add_f32 v[118:119], v[118:119], v[102:103]
    v_pk_add_f32 v[116:117], v[116:117], v[68:69]
    v_pk_add_f32 v[118:119], v[118:119], v[70:71]
    s_or_b64 vcc, vcc, s[62:63]
    v_cndmask_b32 v14, v14, v12, vcc
    s_waitcnt lgkmcnt(0)
    s_barrier
    v_pk_mul_f32 v[112:113], v[112:113], v[14:15] op_sel:[0,0] op_sel_hi:[1,0]
    v_pk_mul_f32 v[114:115], v[114:115], v[14:15] op_sel:[0,0] op_sel_hi:[1,0]
    v_pk_mul_f32 v[116:117], v[116:117], v[14:15] op_sel:[0,0] op_sel_hi:[1,0]
    v_pk_mul_f32 v[118:119], v[118:119], v[14:15] op_sel:[0,0] op_sel_hi:[1,0]
    v_cvt_pk_bf16_f32 v160, v112, v113
    v_cvt_pk_bf16_f32 v161, v114, v115
    v_cvt_pk_bf16_f32 v162, v116, v117
    v_cvt_pk_bf16_f32 v163, v118, v119
    buffer_store_dwordx4 v[160:163], v2, s[28:31], s54 offen sc1
    v_pk_add_f32 v[72:73], v[72:73], v[88:89]
    v_pk_add_f32 v[120:121], v[120:121], v[104:105]
    v_pk_add_f32 v[74:75], v[74:75], v[90:91]
    v_pk_add_f32 v[122:123], v[122:123], v[106:107]
    v_pk_add_f32 v[120:121], v[120:121], v[72:73]
    v_pk_add_f32 v[122:123], v[122:123], v[74:75]
    v_pk_mul_f32 v[120:121], v[120:121], v[14:15] op_sel:[0,0] op_sel_hi:[1,0]
    v_pk_mul_f32 v[122:123], v[122:123], v[14:15] op_sel:[0,0] op_sel_hi:[1,0]
    v_pk_mul_f32 v[124:125], v[124:125], v[14:15] op_sel:[0,0] op_sel_hi:[1,0]
    v_pk_mul_f32 v[126:127], v[126:127], v[14:15] op_sel:[0,0] op_sel_hi:[1,0]
    v_cvt_pk_bf16_f32 v164, v120, v121
    v_cvt_pk_bf16_f32 v165, v122, v123
    s_mov_b32 exec_lo, -1
    s_mov_b32 exec_hi, 0
    v_cvt_pk_bf16_f32 v166, v124, v125
    v_cvt_pk_bf16_f32 v167, v126, v127
    s_mov_b64 exec, -1
    buffer_store_dwordx4 v[164:167], v2, s[28:31], s54 offen offset:1024 sc1
    v_pk_add_f32 v[12:13], v[112:113], v[114:115]
    v_pk_add_f32 v[12:13], v[12:13], v[116:117]
    v_pk_add_f32 v[12:13], v[12:13], v[118:119]
    v_pk_add_f32 v[12:13], v[12:13], v[120:121]
    v_pk_add_f32 v[12:13], v[12:13], v[122:123]
    v_pk_add_f32 v[12:13], v[12:13], v[124:125]
    v_pk_add_f32 v[12:13], v[12:13], v[126:127]
    v_add_f32 v12, v12, v13
    s_movk_i32 s54, 0x207
    v_cmp_class_f32_e64 vcc, v12, s54
    s_nop 1
    s_cbranch_vccz L_wo
    s_branch L_slow
L_att_fin:
    v_mov_b32 v14, v124
    v_mov_b32 v15, v124
    s_lshl_b32 s54, s48, 4
    s_add_u32 s54, s54, s42
    v_permlane32_swap_b32 v14, v15
    v_rcp_f32 v14, v15
    s_lshl_b32 s54, s54, 11
    s_add_u32 s54, s54, s47
    s_add_u32 s54, s54, 0x00200000
    v_pk_mul_f32 v[112:113], v[112:113], v[14:15] op_sel:[0,0] op_sel_hi:[1,0]
    v_pk_mul_f32 v[114:115], v[114:115], v[14:15] op_sel:[0,0] op_sel_hi:[1,0]
    v_pk_mul_f32 v[116:117], v[116:117], v[14:15] op_sel:[0,0] op_sel_hi:[1,0]
    v_pk_mul_f32 v[118:119], v[118:119], v[14:15] op_sel:[0,0] op_sel_hi:[1,0]
    v_cvt_pk_bf16_f32 v160, v112, v113
    v_cvt_pk_bf16_f32 v161, v114, v115
    v_cvt_pk_bf16_f32 v162, v116, v117
    v_cvt_pk_bf16_f32 v163, v118, v119
    buffer_store_dwordx4 v[160:163], v2, s[28:31], s54 offen sc1
    v_pk_mul_f32 v[120:121], v[120:121], v[14:15] op_sel:[0,0] op_sel_hi:[1,0]
    v_pk_mul_f32 v[122:123], v[122:123], v[14:15] op_sel:[0,0] op_sel_hi:[1,0]
    v_pk_mul_f32 v[124:125], v[124:125], v[14:15] op_sel:[0,0] op_sel_hi:[1,0]
    v_pk_mul_f32 v[126:127], v[126:127], v[14:15] op_sel:[0,0] op_sel_hi:[1,0]
    v_mov_b32 v166, 0
    v_mov_b32 v167, 0
    v_cvt_pk_bf16_f32 v164, v120, v121
    v_cvt_pk_bf16_f32 v165, v122, v123
    s_mov_b32 exec_lo, -1
    s_mov_b32 exec_hi, 0
    v_cvt_pk_bf16_f32 v166, v124, v125
    v_cvt_pk_bf16_f32 v167, v126, v127
    s_mov_b64 exec, -1
    buffer_store_dwordx4 v[164:167], v2, s[28:31], s54 offen offset:1024 sc1
    s_branch L_wo
L_A_later:
    s_mov_b32 s62, 0x3fb8aa3b
    s_mov_b32 s63, 0x358637bd
    s_add_u32 s6, s51, s4
    s_add_u32 s6, s6, 0x00016000
    s_mov_b32 s96, 0
    s_barrier
L_A_redo:
    s_mul_i32 s94, s48, 28672
    s_add_u32 s94, s94, s47
    s_sub_u32 s94, s94, 0x1000000
    buffer_load_dwordx4 v[32:35], v2, s[28:31], s94 offen offset:0 sc1
    buffer_load_dwordx4 v[36:39], v2, s[28:31], s94 offen offset:1024 sc1
    v_lshrrev_b32 v12, 5, v1
    v_mul_u32_u24 v12, 1792, v12
    v_and_b32 v13, 31, v1
    v_lshl_add_u32 v12, v13, 3, v12
    s_mul_i32 s54, s48, 3584
    s_add_u32 s54, s54, s47
    s_add_u32 s54, s54, 0xff800000
    buffer_load_dwordx2 v[176:177], v12, s[28:31], s54 offen offset:0 sc1
    buffer_load_dwordx2 v[178:179], v12, s[28:31], s54 offen offset:256 sc1
    buffer_load_dwordx2 v[180:181], v12, s[28:31], s54 offen offset:512 sc1
    buffer_load_dwordx2 v[182:183], v12, s[28:31], s54 offen offset:768 sc1
    buffer_load_dwordx2 v[184:185], v12, s[28:31], s54 offen offset:1024 sc1
    buffer_load_dwordx2 v[186:187], v12, s[28:31], s54 offen offset:1280 sc1
    buffer_load_dwordx2 v[188:189], v12, s[28:31], s54 offen offset:1536 sc1
    buffer_load_dwordx4 v[40:43], v2, s[28:31], s94 offen offset:2048 sc1
    buffer_load_dwordx4 v[44:47], v2, s[28:31], s94 offen offset:3072 sc1
    s_add_u32 s94, s94, 4096
    buffer_load_dwordx4 v[48:51], v2, s[28:31], s94 offen offset:0 sc1
    buffer_load_dwordx4 v[52:55], v2, s[28:31], s94 offen offset:1024 sc1
    buffer_load_dwordx4 v[56:59], v2, s[28:31], s94 offen offset:2048 sc1
    buffer_load_dwordx4 v[60:63], v2, s[28:31], s94 offen offset:3072 sc1
    s_add_u32 s94, s94, 4096
    buffer_load_dwordx4 v[64:67], v2, s[28:31], s94 offen offset:0 sc1
    buffer_load_dwordx4 v[68:71], v2, s[28:31], s94 offen offset:1024 sc1
    buffer_load_dwordx4 v[72:75], v2, s[28:31], s94 offen offset:2048 sc1
    buffer_load_dwordx4 v[76:79], v2, s[28:31], s94 offen offset:3072 sc1
    ds_read_b64_tr_b16 v[192:193], v3 offset:0
    ds_read_b64_tr_b16 v[194:195], v3 offset:512
    ds_read_b64_tr_b16 v[196:197], v4 offset:0
    ds_read_b64_tr_b16 v[198:199], v4 offset:512
    ds_read_b64_tr_b16 v[200:201], v3 offset:2048
    ds_read_b64_tr_b16 v[202:203], v3 offset:2560
    ds_read_b64_tr_b16 v[204:205], v4 offset:2048
    ds_read_b64_tr_b16 v[206:207], v4 offset:2560
    s_waitcnt vmcnt(18) lgkmcnt(4)
    v_mfma_f32_32x32x16_bf16 v[144:159], v[32:35], v[192:195], 0
    v_mfma_f32_32x32x16_bf16 v[160:175], v[32:35], v[196:199], 0
    s_add_u32 s94, s94, 4096
    buffer_load_dwordx4 v[80:83], v2, s[28:31], s94 offen offset:0 sc1
    ds_read_b64_tr_b16 v[192:193], v3 offset:4096
    ds_read_b64_tr_b16 v[194:195], v3 offset:4608
    ds_read_b64_tr_b16 v[196:197], v4 offset:4096
    ds_read_b64_tr_b16 v[198:199], v4 offset:4608
    s_waitcnt vmcnt(18) lgkmcnt(4)
    v_mfma_f32_32x32x16_bf16 v[144:159], v[36:39], v[200:203], v[144:159]
    v_mfma_f32_32x32x16_bf16 v[160:175], v[36:39], v[204:207], v[160:175]
    buffer_load_dwordx4 v[84:87], v2, s[28:31], s94 offen offset:1024 sc1
    ds_read_b64_tr_b16 v[200:201], v3 offset:6144
    ds_read_b64_tr_b16 v[202:203], v3 offset:6656
    ds_read_b64_tr_b16 v[204:205], v4 offset:6144
    ds_read_b64_tr_b16 v[206:207], v4 offset:6656
    s_waitcnt vmcnt(11) lgkmcnt(4)
    v_mfma_f32_32x32x16_bf16 v[144:159], v[40:43], v[192:195], v[144:159]
    v_mfma_f32_32x32x16_bf16 v[160:175], v[40:43], v[196:199], v[160:175]
    buffer_load_dwordx4 v[88:91], v2, s[28:31], s94 offen offset:2048 sc1
    v_pk_add_f32 v[176:177], v[176:177], v[178:179]
    v_pk_add_f32 v[176:177], v[176:177], v[180:181]
    v_pk_add_f32 v[176:177], v[176:177], v[182:183]
    v_pk_add_f32 v[176:177], v[176:177], v[184:185]
    v_pk_add_f32 v[176:177], v[176:177], v[186:187]
    v_pk_add_f32 v[176:177], v[176:177], v[188:189]
    ds_read_b64_tr_b16 v[192:193], v3 offset:8192
    ds_read_b64_tr_b16 v[194:195], v3 offset:8704
    ds_read_b64_tr_b16 v[196:197], v4 offset:8192
    ds_read_b64_tr_b16 v[198:199], v4 offset:8704
    s_waitcnt vmcnt(11) lgkmcnt(4)
    v_mfma_f32_32x32x16_bf16 v[144:159], v[44:47], v[200:203], v[144:159]
    v_mfma_f32_32x32x16_bf16 v[160:175], v[44:47], v[204:207], v[160:175]
    buffer_load_dwordx4 v[92:95], v2, s[28:31], s94 offen offset:3072 sc1
    v_mov_b32 v14, v176
    v_mov_b32 v15, v177
    s_nop 0
    v_permlane32_swap_b32 v14, v176
    v_permlane32_swap_b32 v15, v177
    v_add_f32 v176, v176, v14
    v_add_f32 v177, v177, v15
    v_mul_f32 v11, 0xbb124925, v176
    v_mul_f32 v177, 0x3b124925, v177
    v_fma_f32 v177, -v11, v11, v177
    v_and_b32 v177, 0x7fffffff, v177
    v_add_f32 v177, 0x3727c5ac, v177
    v_rsq_f32 v10, v177
    s_lshl_b32 s53, s40, 8
    s_add_u32 s53, s53, 162560
    v_and_b32 v14, 31, v1
    v_lshl_add_u32 v14, v14, 2, s53
    v_lshrrev_b32 v15, 5, v1
    v_lshl_add_u32 v15, v15, 4, s53
    ds_write_b32 v14, v10
    ds_write_b32 v14, v11 offset:128
    ds_read_b64_tr_b16 v[200:201], v3 offset:10240
    ds_read_b64_tr_b16 v[202:203], v3 offset:10752
    ds_read_b64_tr_b16 v[204:205], v4 offset:10240
    ds_read_b64_tr_b16 v[206:207], v4 offset:10752
    s_waitcnt vmcnt(11) lgkmcnt(6)
    v_mfma_f32_32x32x16_bf16 v[144:159], v[48:51], v[192:195], v[144:159]
    v_mfma_f32_32x32x16_bf16 v[160:175], v[48:51], v[196:199], v[160:175]
    s_add_u32 s94, s94, 4096
    buffer_load_dwordx4 v[96:99], v2, s[28:31], s94 offen offset:0 sc1
    ds_read_b64_tr_b16 v[192:193], v3 offset:12288
    ds_read_b64_tr_b16 v[194:195], v3 offset:12800
    ds_read_b64_tr_b16 v[196:197], v4 offset:12288
    ds_read_b64_tr_b16 v[198:199], v4 offset:12800
    s_waitcnt vmcnt(11) lgkmcnt(4)
    v_mfma_f32_32x32x16_bf16 v[144:159], v[52:55], v[200:203], v[144:159]
    v_mfma_f32_32x32x16_bf16 v[160:175], v[52:55], v[204:207], v[160:175]
    buffer_load_dwordx4 v[100:103], v2, s[28:31], s94 offen offset:1024 sc1
    ds_read_b128 v[208:211], v15 offset:0
    ds_read_b128 v[212:215], v15 offset:32
    ds_read_b128 v[216:219], v15 offset:64
    ds_read_b128 v[220:223], v15 offset:96
    ds_read_b64_tr_b16 v[200:201], v3 offset:14336
    ds_read_b64_tr_b16 v[202:203], v3 offset:14848
    ds_read_b64_tr_b16 v[204:205], v4 offset:14336
    ds_read_b64_tr_b16 v[206:207], v4 offset:14848
    s_waitcnt vmcnt(11) lgkmcnt(8)
    v_mfma_f32_32x32x16_bf16 v[144:159], v[56:59], v[192:195], v[144:159]
    v_mfma_f32_32x32x16_bf16 v[160:175], v[56:59], v[196:199], v[160:175]
    buffer_load_dwordx4 v[104:107], v2, s[28:31], s94 offen offset:2048 sc1
    ds_read_b64_tr_b16 v[192:193], v3 offset:16384
    ds_read_b64_tr_b16 v[194:195], v3 offset:16896
    ds_read_b64_tr_b16 v[196:197], v4 offset:16384
    ds_read_b64_tr_b16 v[198:199], v4 offset:16896
    s_waitcnt vmcnt(11) lgkmcnt(4)
    v_mfma_f32_32x32x16_bf16 v[144:159], v[60:63], v[200:203], v[144:159]
    v_mfma_f32_32x32x16_bf16 v[160:175], v[60:63], v[204:207], v[160:175]
    buffer_load_dwordx4 v[108:111], v2, s[28:31], s94 offen offset:3072 sc1
    ds_read_b128 v[224:227], v15 offset:128
    ds_read_b128 v[228:231], v15 offset:160
    ds_read_b128 v[232:235], v15 offset:192
    ds_read_b128 v[236:239], v15 offset:224
    ds_read_b64_tr_b16 v[200:201], v3 offset:18432
    ds_read_b64_tr_b16 v[202:203], v3 offset:18944
    ds_read_b64_tr_b16 v[204:205], v4 offset:18432
    ds_read_b64_tr_b16 v[206:207], v4 offset:18944
    s_waitcnt vmcnt(11) lgkmcnt(8)
    v_mfma_f32_32x32x16_bf16 v[144:159], v[64:67], v[192:195], v[144:159]
    v_mfma_f32_32x32x16_bf16 v[160:175], v[64:67], v[196:199], v[160:175]
    s_add_u32 s94, s94, 4096
    buffer_load_dwordx4 v[112:115], v2, s[28:31], s94 offen offset:0 sc1
    ds_read_b64_tr_b16 v[192:193], v3 offset:20480
    ds_read_b64_tr_b16 v[194:195], v3 offset:20992
    ds_read_b64_tr_b16 v[196:197], v4 offset:20480
    ds_read_b64_tr_b16 v[198:199], v4 offset:20992
    s_waitcnt vmcnt(11) lgkmcnt(4)
    v_mfma_f32_32x32x16_bf16 v[144:159], v[68:71], v[200:203], v[144:159]
    v_mfma_f32_32x32x16_bf16 v[160:175], v[68:71], v[204:207], v[160:175]
    buffer_load_dwordx4 v[116:119], v2, s[28:31], s94 offen offset:1024 sc1
    v_and_b32 v14, 31, v1
    v_lshlrev_b32 v14, 2, v14
    v_add_u32 v14, 160768, v14
    ds_read2_b32 v[176:177], v14 offset0:0 offset1:64
    ds_read2_b32 v[178:179], v14 offset0:32 offset1:96
    ds_read_b64_tr_b16 v[200:201], v3 offset:22528
    ds_read_b64_tr_b16 v[202:203], v3 offset:23040
    ds_read_b64_tr_b16 v[204:205], v4 offset:22528
    ds_read_b64_tr_b16 v[206:207], v4 offset:23040
    s_waitcnt vmcnt(11) lgkmcnt(6)
    v_mfma_f32_32x32x16_bf16 v[144:159], v[72:75], v[192:195], v[144:159]
    v_mfma_f32_32x32x16_bf16 v[160:175], v[72:75], v[196:199], v[160:175]
    buffer_load_dwordx4 v[120:123], v2, s[28:31], s94 offen offset:2048 sc1
    ds_read_b64_tr_b16 v[192:193], v3 offset:24576
    ds_read_b64_tr_b16 v[194:195], v3 offset:25088
    ds_read_b64_tr_b16 v[196:197], v4 offset:24576
    ds_read_b64_tr_b16 v[198:199], v4 offset:25088
    s_waitcnt vmcnt(11) lgkmcnt(4)
    v_mfma_f32_32x32x16_bf16 v[144:159], v[76:79], v[200:203], v[144:159]
    v_mfma_f32_32x32x16_bf16 v[160:175], v[76:79], v[204:207], v[160:175]
    buffer_load_dwordx4 v[124:127], v2, s[28:31], s94 offen offset:3072 sc1
    v_add_f32 v12, v176, v177
    v_add_f32 v13, v178, v179
    ds_read_b64_tr_b16 v[200:201], v3 offset:26624
    ds_read_b64_tr_b16 v[202:203], v3 offset:27136
    ds_read_b64_tr_b16 v[204:205], v4 offset:26624
    ds_read_b64_tr_b16 v[206:207], v4 offset:27136
    s_waitcnt vmcnt(11) lgkmcnt(4)
    v_mfma_f32_32x32x16_bf16 v[144:159], v[80:83], v[192:195], v[144:159]
    v_mfma_f32_32x32x16_bf16 v[160:175], v[80:83], v[196:199], v[160:175]
    s_add_u32 s94, s94, 4096
    buffer_load_dwordx4 v[128:131], v2, s[28:31], s94 offen offset:0 sc1
    ds_read_b64_tr_b16 v[192:193], v3 offset:28672
    ds_read_b64_tr_b16 v[194:195], v3 offset:29184
    ds_read_b64_tr_b16 v[196:197], v4 offset:28672
    ds_read_b64_tr_b16 v[198:199], v4 offset:29184
    s_waitcnt vmcnt(11) lgkmcnt(4)
    v_mfma_f32_32x32x16_bf16 v[144:159], v[84:87], v[200:203], v[144:159]
    v_mfma_f32_32x32x16_bf16 v[160:175], v[84:87], v[204:207], v[160:175]
    buffer_load_dwordx4 v[132:135], v2, s[28:31], s94 offen offset:1024 sc1
    ds_read_b64_tr_b16 v[200:201], v3 offset:30720
    ds_read_b64_tr_b16 v[202:203], v3 offset:31232
    ds_read_b64_tr_b16 v[204:205], v4 offset:30720
    ds_read_b64_tr_b16 v[206:207], v4 offset:31232
    s_waitcnt vmcnt(11) lgkmcnt(4)
    v_mfma_f32_32x32x16_bf16 v[144:159], v[88:91], v[192:195], v[144:159]
    v_mfma_f32_32x32x16_bf16 v[160:175], v[88:91], v[196:199], v[160:175]
    buffer_load_dwordx4 v[136:139], v2, s[28:31], s94 offen offset:2048 sc1
    ds_read_b64_tr_b16 v[192:193], v3 offset:32768
    ds_read_b64_tr_b16 v[194:195], v3 offset:33280
    ds_read_b64_tr_b16 v[196:197], v4 offset:32768
    ds_read_b64_tr_b16 v[198:199], v4 offset:33280
    s_waitcnt vmcnt(11) lgkmcnt(4)
    v_mfma_f32_32x32x16_bf16 v[144:159], v[92:95], v[200:203], v[144:159]
    v_mfma_f32_32x32x16_bf16 v[160:175], v[92:95], v[204:207], v[160:175]
    buffer_load_dwordx4 v[140:143], v2, s[28:31], s94 offen offset:3072 sc1
    ds_read_b64_tr_b16 v[200:201], v3 offset:34816
    ds_read_b64_tr_b16 v[202:203], v3 offset:35328
    ds_read_b64_tr_b16 v[204:205], v4 offset:34816
    ds_read_b64_tr_b16 v[206:207], v4 offset:35328
    s_waitcnt vmcnt(11) lgkmcnt(4)
    v_mfma_f32_32x32x16_bf16 v[144:159], v[96:99], v[192:195], v[144:159]
    v_mfma_f32_32x32x16_bf16 v[160:175], v[96:99], v[196:199], v[160:175]
    ds_read_b64_tr_b16 v[192:193], v3 offset:36864
    ds_read_b64_tr_b16 v[194:195], v3 offset:37376
    ds_read_b64_tr_b16 v[196:197], v4 offset:36864
    ds_read_b64_tr_b16 v[198:199], v4 offset:37376
    s_waitcnt vmcnt(10) lgkmcnt(4)
    v_mfma_f32_32x32x16_bf16 v[144:159], v[100:103], v[200:203], v[144:159]
    v_mfma_f32_32x32x16_bf16 v[160:175], v[100:103], v[204:207], v[160:175]
    ds_read_b64_tr_b16 v[200:201], v3 offset:38912
    ds_read_b64_tr_b16 v[202:203], v3 offset:39424
    ds_read_b64_tr_b16 v[204:205], v4 offset:38912
    ds_read_b64_tr_b16 v[206:207], v4 offset:39424
    s_waitcnt vmcnt(9) lgkmcnt(4)
    v_mfma_f32_32x32x16_bf16 v[144:159], v[104:107], v[192:195], v[144:159]
    v_mfma_f32_32x32x16_bf16 v[160:175], v[104:107], v[196:199], v[160:175]
    ds_read_b64_tr_b16 v[192:193], v3 offset:40960
    ds_read_b64_tr_b16 v[194:195], v3 offset:41472
    ds_read_b64_tr_b16 v[196:197], v4 offset:40960
    ds_read_b64_tr_b16 v[198:199], v4 offset:41472
    s_waitcnt vmcnt(8) lgkmcnt(4)
    v_mfma_f32_32x32x16_bf16 v[144:159], v[108:111], v[200:203], v[144:159]
    v_mfma_f32_32x32x16_bf16 v[160:175], v[108:111], v[204:207], v[160:175]
    ds_read_b64_tr_b16 v[200:201], v3 offset:43008
    ds_read_b64_tr_b16 v[202:203], v3 offset:43520
    ds_read_b64_tr_b16 v[204:205], v4 offset:43008
    ds_read_b64_tr_b16 v[206:207], v4 offset:43520
    s_waitcnt vmcnt(7) lgkmcnt(4)
    v_mfma_f32_32x32x16_bf16 v[144:159], v[112:115], v[192:195], v[144:159]
    v_mfma_f32_32x32x16_bf16 v[160:175], v[112:115], v[196:199], v[160:175]
    ds_read_b64_tr_b16 v[192:193], v3 offset:45056
    ds_read_b64_tr_b16 v[194:195], v3 offset:45568
    ds_read_b64_tr_b16 v[196:197], v4 offset:45056
    ds_read_b64_tr_b16 v[198:199], v4 offset:45568
    s_waitcnt vmcnt(6) lgkmcnt(4)
    v_mfma_f32_32x32x16_bf16 v[144:159], v[116:119], v[200:203], v[144:159]
    v_mfma_f32_32x32x16_bf16 v[160:175], v[116:119], v[204:207], v[160:175]
    ds_read_b64_tr_b16 v[200:201], v3 offset:47104
    ds_read_b64_tr_b16 v[202:203], v3 offset:47616
    ds_read_b64_tr_b16 v[204:205], v4 offset:47104
    ds_read_b64_tr_b16 v[206:207], v4 offset:47616
    s_waitcnt vmcnt(5) lgkmcnt(4)
    v_mfma_f32_32x32x16_bf16 v[144:159], v[120:123], v[192:195], v[144:159]
    v_mfma_f32_32x32x16_bf16 v[160:175], v[120:123], v[196:199], v[160:175]
    ds_read_b64_tr_b16 v[192:193], v3 offset:49152
    ds_read_b64_tr_b16 v[194:195], v3 offset:49664
    ds_read_b64_tr_b16 v[196:197], v4 offset:49152
    ds_read_b64_tr_b16 v[198:199], v4 offset:49664
    s_waitcnt vmcnt(4) lgkmcnt(4)
    v_mfma_f32_32x32x16_bf16 v[144:159], v[124:127], v[200:203], v[144:159]
    v_mfma_f32_32x32x16_bf16 v[160:175], v[124:127], v[204:207], v[160:175]
    ds_read_b64_tr_b16 v[200:201], v3 offset:51200
    ds_read_b64_tr_b16 v[202:203], v3 offset:51712
    ds_read_b64_tr_b16 v[204:205], v4 offset:51200
    ds_read_b64_tr_b16 v[206:207], v4 offset:51712
    s_waitcnt vmcnt(3) lgkmcnt(4)
    v_mfma_f32_32x32x16_bf16 v[144:159], v[128:131], v[192:195], v[144:159]
    v_mfma_f32_32x32x16_bf16 v[160:175], v[128:131], v[196:199], v[160:175]
    ds_read_b64_tr_b16 v[192:193], v3 offset:53248
    ds_read_b64_tr_b16 v[194:195], v3 offset:53760
    ds_read_b64_tr_b16 v[196:197], v4 offset:53248
    ds_read_b64_tr_b16 v[198:199], v4 offset:53760
    s_waitcnt vmcnt(2) lgkmcnt(4)
    v_mfma_f32_32x32x16_bf16 v[144:159], v[132:135], v[200:203], v[144:159]
    v_mfma_f32_32x32x16_bf16 v[160:175], v[132:135], v[204:207], v[160:175]
    ds_read_b64_tr_b16 v[200:201], v3 offset:55296
    ds_read_b64_tr_b16 v[202:203], v3 offset:55808
    ds_read_b64_tr_b16 v[204:205], v4 offset:55296
    ds_read_b64_tr_b16 v[206:207], v4 offset:55808
    s_waitcnt vmcnt(1) lgkmcnt(4)
    v_mfma_f32_32x32x16_bf16 v[144:159], v[136:139], v[192:195], v[144:159]
    v_mfma_f32_32x32x16_bf16 v[160:175], v[136:139], v[196:199], v[160:175]
    s_waitcnt vmcnt(0) lgkmcnt(0)
    v_mfma_f32_32x32x16_bf16 v[144:159], v[140:143], v[200:203], v[144:159]
    v_mfma_f32_32x32x16_bf16 v[160:175], v[140:143], v[204:207], v[160:175]
    s_cmp_lg_u32 s96, 0
    s_cbranch_scc1 Ldl_133
    s_cmp_eq_u32 s45, 0
    s_cbranch_scc1 Ldl_133
    v_mov_b32 v14, 1
    s_add_u32 s54, s5, s87
    s_add_u32 s53, s51, s54
    s_add_u32 s53, s53, 0x00016000
    s_mov_b64 exec, 1
    buffer_atomic_add v14, off, s[28:31], s53 sc1
    s_mov_b64 exec, -1
Ldl_133:
    s_branch L_A_epi
L_slow:
    v_lshlrev_b32 v15, 7, v1
    s_mov_b32 s52, 200000
    s_mov_b64 exec, 15
Lpc_134:
    v_mov_b32 v14, 0
    buffer_atomic_add v14, v15, s[28:31], s6 offen sc0 sc1
    s_waitcnt vmcnt(0)
    v_cmp_gt_u32 vcc, 16, v14
    s_nop 1
    s_cbranch_vccz Lpd_135
    s_sub_u32 s52, s52, 1
    s_cmp_eq_u32 s52, 0
    s_cbranch_scc0 Lpc_134
    s_endpgm
Lpd_135:
    s_mov_b64 exec, -1
    buffer_inv sc1
    s_waitcnt vmcnt(0)
    s_mov_b32 s96, 1
    s_lshl_b32 s95, s42, 18
    s_add_u32 s95, s95, s47
    s_add_u32 s95, s95, 0x00400000
    s_mov_b32 s94, s95
    v_mov_b32 v232, 0xff800000
    s_mov_b32 exec_lo, 0
    s_mov_b32 exec_hi, -1
    v_mov_b32 v62, 0
    v_mov_b32 v63, 0
    s_mov_b64 exec, -1
    s_mov_b32 s93, 64
L_slow1:
    buffer_load_dwordx4 v[168:171], v2, s[28:31], s94 offen sc1
    buffer_load_dwordx4 v[172:175], v2, s[28:31], s94 offen offset:1024 sc1
    s_add_u32 s94, s94, 4096
    s_waitcnt vmcnt(0)
    v_mfma_f32_32x32x16_bf16 v[128:143], v[168:171], v[56:59], 0
    v_mfma_f32_32x32x16_bf16 v[128:143], v[172:175], v[60:63], v[128:143]
    s_nop 11
    v_max3_f32 v232, v128, v129, v232
    v_max3_f32 v232, v130, v131, v232
    v_max3_f32 v232, v132, v133, v232
    v_max3_f32 v232, v134, v135, v232
    v_max3_f32 v232, v136, v137, v232
    v_max3_f32 v232, v138, v139, v232
    v_max3_f32 v232, v140, v141, v232
    v_max3_f32 v232, v142, v143, v232
    s_sub_u32 s93, s93, 1
    s_cmp_lg_u32 s93, 0
    s_cbranch_scc1 L_slow1
    v_mov_b32 v233, v232
    s_nop 1
    v_permlane32_swap_b32 v232, v233
    v_max_f32 v232, v232, v233
    v_sub_f32 v232, 0, v232
    v_and_b32 v233, 0xffff0000, v232
    v_sub_f32 v232, v232, v233
    v_and_b32 v234, 0xffff0000, v232
    v_sub_f32 v232, v232, v234
    v_lshrrev_b32 v233, 16, v233
    s_mov_b32 exec_lo, 0
    s_mov_b32 exec_hi, -1
    v_or_b32 v62, v233, v234
    v_lshrrev_b32 v63, 16, v232
    s_mov_b64 exec, -1
    v_mov_b32 v112, 0
    v_mov_b32 v113, 0
    v_mov_b32 v114, 0
    v_mov_b32 v115, 0
    v_mov_b32 v116, 0
    v_mov_b32 v117, 0
    v_mov_b32 v118, 0
    v_mov_b32 v119, 0
    v_mov_b32 v120, 0
    v_mov_b32 v121, 0
    v_mov_b32 v122, 0
    v_mov_b32 v123, 0
    v_mov_b32 v124, 0
    v_mov_b32 v125, 0
    v_mov_b32 v126, 0
    v_mov_b32 v127, 0
    s_mov_b32 s94, s95
    s_mov_b32 s93, 64
L_slow2:
    buffer_load_dwordx4 v[168:171], v2, s[28:31], s94 offen offset:0 sc1
    buffer_load_dwordx4 v[172:175], v2, s[28:31], s94 offen offset:1024 sc1
    buffer_load_dwordx4 v[176:179], v2, s[28:31], s94 offen offset:2048 sc1
    buffer_load_dwordx4 v[180:183], v2, s[28:31], s94 offen offset:3072 sc1
    s_add_u32 s94, s94, 4096
    s_waitcnt vmcnt(0)
    v_mfma_f32_32x32x16_bf16 v[128:143], v[168:171], v[56:59], 0
    v_mfma_f32_32x32x16_bf16 v[128:143], v[172:175], v[60:63], v[128:143]
    s_nop 11
    v_exp_f32 v128, v128
    v_exp_f32 v129, v129
    v_exp_f32 v130, v130
    v_exp_f32 v131, v131
    v_exp_f32 v132, v132
    v_exp_f32 v133, v133
    v_exp_f32 v134, v134
    v_exp_f32 v135, v135
    v_exp_f32 v136, v136
    v_exp_f32 v137, v137
    v_exp_f32 v138, v138
    v_exp_f32 v139, v139
    v_exp_f32 v140, v140
    v_exp_f32 v141, v141
    v_exp_f32 v142, v142
    v_exp_f32 v143, v143
    v_cvt_pk_bf16_f32 v160, v128, v129
    v_cvt_pk_bf16_f32 v161, v130, v131
    v_cvt_pk_bf16_f32 v162, v132, v133
    v_cvt_pk_bf16_f32 v163, v134, v135
    v_cvt_pk_bf16_f32 v164, v136, v137
    v_cvt_pk_bf16_f32 v165, v138, v139
    v_cvt_pk_bf16_f32 v166, v140, v141
    v_cvt_pk_bf16_f32 v167, v142, v143
    v_mfma_f32_32x32x16_bf16 v[112:127], v[176:179], v[160:163], v[112:127]
    s_nop 0
    v_mfma_f32_32x32x16_bf16 v[112:127], v[180:183], v[164:167], v[112:127]
    s_sub_u32 s93, s93, 1
    s_cmp_lg_u32 s93, 0
    s_cbranch_scc1 L_slow2
    s_nop 11
    s_branch L_att_fin
Lbad_119:
    s_cmp_ge_u32 s96, 3
    s_cbranch_scc1 Lok_120
    s_add_u32 s96, s96, 1
    v_lshlrev_b32 v15, 7, v1
    s_mov_b32 s52, 200000
    s_mov_b64 exec, 15
Lpc_136:
    v_mov_b32 v14, 0
    buffer_atomic_add v14, v15, s[28:31], s6 offen sc0 sc1
    s_waitcnt vmcnt(0)
    v_cmp_gt_u32 vcc, 14, v14
    s_nop 1
    s_cbranch_vccz Lpd_137
    s_sub_u32 s52, s52, 1
    s_cmp_eq_u32 s52, 0
    s_cbranch_scc0 Lpc_136
    s_endpgm
Lpd_137:
    s_mov_b64 exec, -1
    buffer_inv sc1
    s_waitcnt vmcnt(0) lgkmcnt(0)
    s_branch L_A_redo
Lbad_121:
    s_cmp_ge_u32 s96, 3
    s_cbranch_scc1 Lok_122
    s_add_u32 s96, s96, 1
    v_lshlrev_b32 v15, 7, v1
    s_mov_b32 s52, 200000
    s_mov_b64 exec, 15
Lpc_138:
    v_mov_b32 v14, 0
    buffer_atomic_add v14, v15, s[28:31], s6 offen sc0 sc1
    s_waitcnt vmcnt(0)
    v_cmp_gt_u32 vcc, 16, v14
    s_nop 1
    s_cbranch_vccz Lpd_139
    s_sub_u32 s52, s52, 1
    s_cmp_eq_u32 s52, 0
    s_cbranch_scc0 Lpc_138
    s_endpgm
Lpd_139:
    s_mov_b64 exec, -1
    buffer_inv sc1
    s_waitcnt vmcnt(0) lgkmcnt(0)
    s_branch L_A_mredo
Lbad_124:
    s_cmp_ge_u32 s96, 3
    s_cbranch_scc1 Lok_125
    s_add_u32 s96, s96, 1
    v_lshlrev_b32 v15, 7, v1
    s_mov_b32 s52, 200000
    s_mov_b64 exec, 15
Lpc_140:
    v_mov_b32 v14, 0
    buffer_atomic_add v14, v15, s[28:31], s6 offen sc0 sc1
    s_waitcnt vmcnt(0)
    v_cmp_gt_u32 vcc, 16, v14
    s_nop 1
    s_cbranch_vccz Lpd_141
    s_sub_u32 s52, s52, 1
    s_cmp_eq_u32 s52, 0
    s_cbranch_scc0 Lpc_140
    s_endpgm
Lpd_141:
    s_mov_b64 exec, -1
    buffer_inv sc1
    s_waitcnt vmcnt(0) lgkmcnt(0)
    s_branch L_wo_redo
Lbad_131:
    s_cmp_ge_u32 s96, 3
    s_cbranch_scc1 Lok_132
    s_add_u32 s96, s96, 1
    v_lshlrev_b32 v15, 7, v1
    s_mov_b32 s52, 200000
    s_mov_b64 exec, 15
Lpc_142:
    v_mov_b32 v14, 0
    buffer_atomic_add v14, v15, s[28:31], s6 offen sc0 sc1
    s_waitcnt vmcnt(0)
    v_cmp_gt_u32 vcc, 14, v14
    s_nop 1
    s_cbranch_vccz Lpd_143
    s_sub_u32 s52, s52, 1
    s_cmp_eq_u32 s52, 0
    s_cbranch_scc0 Lpc_142
    s_endpgm
Lpd_143:
    s_mov_b64 exec, -1
    buffer_inv sc1
    s_waitcnt vmcnt(0) lgkmcnt(0)
    s_branch L_B_redo
L_fin:
L_end:
    s_endpgm
L_code_end:

.section .rodata,"a"
.p2align 6
.amdhsa_kernel interleave_layers__linear_attn_block__softmax_full_mha__prompt_kernel
  .amdhsa_next_free_vgpr 256
  .amdhsa_next_free_sgpr 102
  .amdhsa_accum_offset 256
  .amdhsa_group_segment_fixed_size 0
  .amdhsa_kernarg_size 72
  .amdhsa_user_sgpr_count 2
  .amdhsa_user_sgpr_kernarg_segment_ptr 1
  .amdhsa_system_sgpr_workgroup_id_x 1
.end_amdhsa_kernel
```
